```python
import torch

def _softmax(x, axis=-1):
    return torch.softmax(x, dim=axis)
def _gelu(x):
    return torch.nn.functional.gelu(x, approximate="tanh")
def _silu(x):
    return torch.nn.functional.silu(x)
def _sigmoid(x):
    return torch.sigmoid(x)
def _layernorm(x, axis=-1, eps=1e-5):
    m = x.mean(dim=axis, keepdim=True)
    v = x.var(dim=axis, keepdim=True, unbiased=False)
    return (x - m) / torch.sqrt(v + eps)
def _scatter_add(tgt, idx, src, axis=0):
    return tgt.clone().index_add_(axis, idx, src)
def _segment_sum(src, seg, n):
    out = torch.zeros((n,) + src.shape[1:], dtype=src.dtype)
    return out.index_add_(0, seg, src)
def _pad(x, pw):
    flat = tuple(v for pair in reversed(pw) for v in pair)
    return torch.nn.functional.pad(x, flat)

kernel_name = 'gather_scatter__edge_featured_mpnn_egc__graph'

def setup_inputs():

    _w = (lambda a: (lambda t: t.to(torch.bfloat16) if t.is_floating_point() else t)(torch.as_tensor(a)))
    N, deg, D, De = 12500, 64, 64, max(0, 1)
    E = N * deg
    return {
        "x": _w((lambda *s: torch.randn(*s, dtype=torch.bfloat16) * 0.2)(N, D)),
        "e_attr": _w((lambda *s: torch.randn(*s, dtype=torch.bfloat16) * 0.2)(E, De)),
        "src": _w((lambda lo, hi, *s: torch.randint(lo, hi, s))(0, N, E).to(torch.int64)),
        "dst": _w((lambda lo, hi, *s: torch.randint(lo, hi, s))(0, N, E).to(torch.int64)),
        "u_w": _w((lambda *s: torch.randn(*s, dtype=torch.bfloat16) * 0.05)(D, D)),
        "v_w": _w((lambda *s: torch.randn(*s, dtype=torch.bfloat16) * 0.05)(D, D)),
        "g_w": _w((lambda *s: torch.randn(*s, dtype=torch.bfloat16) * 0.2)(2 * D + De, D)),
    }

def reference(x, e_attr, src, dst, u_w, v_w, g_w):
    N, D = x.shape
    g_in = torch.concatenate([x[dst], x[src], e_attr], axis=-1)
    eta = _sigmoid(g_in @ g_w)
    hv = x @ v_w
    msg = eta * hv[src]
    agg = _segment_sum(msg, dst, N)
    return _silu(x @ u_w + agg)
```

```asm
; @launch kernel=egc_bin_kernel grid=(250,1,1) block=(768,1,1) lds=71424
; @launch kernel=egc_main_kernel grid=(256,1,1) block=(1024,1,1) lds=154624
.amdgcn_target "amdgcn-amd-amdhsa--gfx950"
.text
.globl egc_bin_kernel
.p2align 12
.type egc_bin_kernel,@function
egc_bin_kernel:
    s_load_dwordx16 s[4:19], s[0:1], 0
    s_load_dwordx2 s[20:21], s[0:1], 72
    s_cmp_ge_u32 s2, 250
    s_cbranch_scc1 K1_END
    s_getpc_b64 s[72:73]
K1_PC:
    v_lshlrev_b32 v120, 4, v0
    s_add_u32 s72, s72, egc_bin_kernel+1024-K1_PC
    s_addc_u32 s73, s73, 0
    global_load_dwordx4 v[124:127], v120, s[72:73]
K1_NCP:
    v_lshrrev_b32 v1, 6, v0
    v_and_b32 v2, 63, v0
    v_readfirstlane_b32 s3, v1
    s_add_u32 s3, s3, 8
    s_cmp_lt_u32 s3, 12
    s_cbranch_scc0 K1_BIN
    s_cmp_ge_u32 s2, 196
    s_cbranch_scc1 K1_SPEC
K1_TGO:
    s_and_b32 s23, s3, 1
    s_bfe_u32 s40, s3, 0x10001
    v_and_b32 v3, 16, v2
    v_lshlrev_b32 v5, 4, v2
    v_lshlrev_b32 v3, 2, v3
    v_xor_b32 v5, v5, v3
    s_lshl_b32 s41, s23, 12
    s_lshl_b32 s42, s3, 12
    s_add_u32 s42, s42, 14080
    s_lshl_b32 s43, s2, 2
    s_add_u32 s43, s43, s3
    s_lshl_b32 s43, s43, 4
    s_sub_u32 s43, s43, 128
    v_lshrrev_b32 v6, 3, v2
    v_lshrrev_b32 v3, 4, v2
    v_add_u32 v6, s43, v6
    v_xor_b32 v3, v3, v2
    v_min_u32 v7, 12491, v6
    v_min_u32 v6, 12499, v6
    v_and_b32 v3, 7, v3
    v_lshlrev_b32 v3, 4, v3
    v_lshl_add_u32 v7, v7, 7, v3
    v_lshl_add_u32 v6, v6, 7, v3
    v_xor_b32 v7, 64, v7
    s_lshl_b32 s44, s3, 11
    s_add_u32 s44, s44, 46848
    s_mov_b32 s30, 8192
    s_mov_b32 s31, 0x20000
    s_mov_b32 m0, s44
    s_waitcnt lgkmcnt(0)
    s_mov_b32 s24, s4
    s_and_b32 s25, s5, 0xffff
    s_mov_b32 s26, 0x186a00
    s_mov_b32 s27, 0x20000
    buffer_load_dwordx4 v6, s[24:27], 0 offen lds
    buffer_load_dwordx4 v7, s[24:27], 0 offen offset:1024 lds
    s_mov_b32 m0, s42
    s_add_u32 s28, s16, 8192
    s_addc_u32 s29, s17, 0
    s_cmp_eq_u32 s2, 249
    s_cselect_b64 s[28:29], s[16:17], s[28:29]
    s_cselect_b64 s[32:33], s[12:13], s[14:15]
    s_cmp_eq_u32 s40, 0
    s_cselect_b64 s[28:29], s[28:29], s[32:33]
    s_and_b32 s29, s29, 0xffff
    buffer_load_dwordx4 v5, s[28:31], s41 offen offset:0 lds
    buffer_load_dwordx4 v5, s[28:31], s41 offen offset:1024 lds
    buffer_load_dwordx4 v5, s[28:31], s41 offen offset:2048 lds
    buffer_load_dwordx4 v5, s[28:31], s41 offen offset:3072 lds
    s_barrier
    s_branch K1_TABLE
K1_BIN:
    s_sub_u32 s3, s3, 12
    v_subrev_u32 v0, 256, v0
    s_mul_i32 s40, s2, 12800
    s_add_u32 s41, s40, 6400
    s_mul_i32 s42, s2, 6400
    s_add_u32 s43, s42, 3200
    v_lshlrev_b32 v3, 4, v0
    v_lshlrev_b32 v4, 3, v0
    v_cmp_gt_u32 vcc, 400, v0
    v_min_u32 v6, 259, v0
    v_mov_b32 v5, 0
    v_mul_u32_u24 v6, 180, v6
    s_mov_b64 s[44:45], vcc
    s_mov_b64 exec, vcc
    ds_write_b32 v6, v5 offset:164
    s_waitcnt lgkmcnt(0)
    s_mov_b32 s24, s10
    s_and_b32 s25, s11, 0xffff
    s_mov_b32 s26, 0x30d400
    s_mov_b32 s27, 0x20000
    buffer_load_dwordx4 v[8:11], v3, s[24:27], s40 offen
    buffer_load_dwordx4 v[12:15], v3, s[24:27], s41 offen
    s_mov_b32 s28, s8
    s_and_b32 s29, s9, 0xffff
    s_mov_b32 s30, 0x30d400
    s_mov_b32 s31, 0x20000
    s_mov_b32 s32, s6
    s_and_b32 s33, s7, 0xffff
    s_mov_b32 s34, 0x186a00
    s_mov_b32 s35, 0x20000
    s_barrier
    buffer_load_dwordx4 v[16:19], v3, s[28:31], s40 offen
    buffer_load_dwordx2 v[24:25], v4, s[32:35], s42 offen
    buffer_load_dwordx4 v[20:23], v3, s[28:31], s41 offen
    buffer_load_dwordx2 v[26:27], v4, s[32:35], s43 offen
    s_mov_b32 s36, s20
    s_and_b32 s37, s21, 0xffff
    s_mov_b32 s38, 0x1f00000
    s_mov_b32 s39, 0x20000
    s_mov_b64 exec, -1
    v_lshrrev_b32 v28, 3, v0
    v_and_b32 v29, 7, v0
    v_mul_u32_u24 v30, 40064, v28
    v_lshl_add_u32 v30, v29, 4, v30
    v_mul_u32_u24 v28, 180, v28
    v_lshl_add_u32 v72, v29, 4, v28
    v_add_u32 v73, 11520, v72
    v_add_u32 v74, 23040, v72
    v_add_u32 v75, 34560, v72
    v_mul_u32_u24 v31, 262146, v29
    v_cmp_eq_u32 vcc, 0, v29
    v_mov_b32 v7, 87382
    v_mov_b32 v1, 180
    v_cndmask_b32 v31, v31, -1, vcc
    v_lshrrev_b32 v76, 1, v0
    v_and_b32 v79, 1, v0
    v_mul_u32_u24 v78, 40064, v76
    v_mul_u32_u24 v76, 180, v76
    v_lshl_add_u32 v78, v79, 4, v78
    v_lshl_add_u32 v77, v79, 4, v76
    v_mul_u32_u24 v79, 262146, v79
    v_add_u32 v79, 2097168, v79
    s_lshl_b32 s55, s2, 5
    s_add_u32 s55, s55, 0x407d00
    s_mov_b64 exec, s[44:45]
    s_mov_b32 s46, 342393
    s_mov_b32 s47, 0xffff0000
    s_movk_i32 s49, 12544
    s_mov_b32 s50, 2621460
    s_mov_b32 s51, 4019572
    s_lshl_b32 s48, s2, 7
    s_add_u32 s48, s48, 0x400000
    s_mov_b32 s54, 0x06020100
    s_waitcnt vmcnt(5)
    v_mul_u32_u24 v8, s46, v8
    v_mul_u32_u24 v9, s46, v9
    v_mul_u32_u24 v10, s46, v10
    v_mul_u32_u24 v11, s46, v11
    v_mul_u32_u24_sdwa v32, v1, v8 dst_sel:DWORD dst_unused:UNUSED_PAD src0_sel:DWORD src1_sel:BYTE_3
    v_mul_u32_u24_sdwa v33, v1, v9 dst_sel:DWORD dst_unused:UNUSED_PAD src0_sel:DWORD src1_sel:BYTE_3
    v_mul_u32_u24_sdwa v34, v1, v10 dst_sel:DWORD dst_unused:UNUSED_PAD src0_sel:DWORD src1_sel:BYTE_3
    v_mul_u32_u24_sdwa v35, v1, v11 dst_sel:DWORD dst_unused:UNUSED_PAD src0_sel:DWORD src1_sel:BYTE_3
    ds_add_rtn_u32 v40, v32, v7 offset:164
    ds_add_rtn_u32 v41, v33, v7 offset:164
    ds_add_rtn_u32 v42, v34, v7 offset:164
    ds_add_rtn_u32 v43, v35, v7 offset:164
    s_waitcnt vmcnt(4)
    v_mul_u32_u24 v12, s46, v12
    v_mul_u32_u24 v13, s46, v13
    v_mul_u32_u24 v14, s46, v14
    v_mul_u32_u24 v15, s46, v15
    v_mul_u32_u24_sdwa v36, v1, v12 dst_sel:DWORD dst_unused:UNUSED_PAD src0_sel:DWORD src1_sel:BYTE_3
    v_mul_u32_u24_sdwa v37, v1, v13 dst_sel:DWORD dst_unused:UNUSED_PAD src0_sel:DWORD src1_sel:BYTE_3
    v_mul_u32_u24_sdwa v38, v1, v14 dst_sel:DWORD dst_unused:UNUSED_PAD src0_sel:DWORD src1_sel:BYTE_3
    v_mul_u32_u24_sdwa v39, v1, v15 dst_sel:DWORD dst_unused:UNUSED_PAD src0_sel:DWORD src1_sel:BYTE_3
    ds_add_rtn_u32 v44, v36, v7 offset:164
    ds_add_rtn_u32 v45, v37, v7 offset:164
    ds_add_rtn_u32 v46, v38, v7 offset:164
    ds_add_rtn_u32 v47, v39, v7 offset:164
    v_mul_hi_u32_u24 v48, s49, v8
    v_mul_hi_u32_u24 v49, s49, v9
    v_mul_hi_u32_u24 v50, s49, v10
    v_mul_hi_u32_u24 v51, s49, v11
    v_mul_hi_u32_u24 v52, s49, v12
    v_mul_hi_u32_u24 v53, s49, v13
    v_mul_hi_u32_u24 v54, s49, v14
    v_mul_hi_u32_u24 v55, s49, v15
    s_waitcnt lgkmcnt(6)
    v_min_u32 v5, s50, v40
    v_min_u32 v6, s50, v41
    v_mad_u32_u16 v32, v5, 4, v32 op_sel:[1,0,0,0]
    v_mad_u32_u16 v33, v6, 4, v33 op_sel:[1,0,0,0]
    v_bfe_u32 v5, v5, 16, 2
    v_bfe_u32 v6, v6, 16, 2
    v_mad_i32_i24 v5, v5, -3, v32
    v_mad_i32_i24 v6, v6, -3, v33
    ds_write_b8 v5, v48 offset:12
    ds_write_b8 v6, v49 offset:12
    s_waitcnt lgkmcnt(6)
    v_min_u32 v5, s50, v42
    v_min_u32 v6, s50, v43
    v_mad_u32_u16 v34, v5, 4, v34 op_sel:[1,0,0,0]
    v_mad_u32_u16 v35, v6, 4, v35 op_sel:[1,0,0,0]
    v_bfe_u32 v5, v5, 16, 2
    v_bfe_u32 v6, v6, 16, 2
    v_mad_i32_i24 v5, v5, -3, v34
    v_mad_i32_i24 v6, v6, -3, v35
    ds_write_b8 v5, v50 offset:12
    ds_write_b8 v6, v51 offset:12
    s_waitcnt lgkmcnt(6)
    v_min_u32 v5, s50, v44
    v_min_u32 v6, s50, v45
    v_mad_u32_u16 v36, v5, 4, v36 op_sel:[1,0,0,0]
    v_mad_u32_u16 v37, v6, 4, v37 op_sel:[1,0,0,0]
    v_bfe_u32 v5, v5, 16, 2
    v_bfe_u32 v6, v6, 16, 2
    v_mad_i32_i24 v5, v5, -3, v36
    v_mad_i32_i24 v6, v6, -3, v37
    ds_write_b8 v5, v52 offset:12
    ds_write_b8 v6, v53 offset:12
    s_waitcnt lgkmcnt(6)
    v_min_u32 v5, s50, v46
    v_min_u32 v6, s50, v47
    v_mad_u32_u16 v38, v5, 4, v38 op_sel:[1,0,0,0]
    v_mad_u32_u16 v39, v6, 4, v39 op_sel:[1,0,0,0]
    v_bfe_u32 v5, v5, 16, 2
    v_bfe_u32 v6, v6, 16, 2
    v_mad_i32_i24 v5, v5, -3, v38
    v_mad_i32_i24 v6, v6, -3, v39
    ds_write_b8 v5, v54 offset:12
    ds_write_b8 v6, v55 offset:12
    v_max3_u32 v5, v40, v41, v42
    v_max3_u32 v6, v43, v44, v45
    v_max3_u32 v5, v46, v47, v5
    v_max_u32 v5, v5, v6
    v_cmp_le_u32 s[52:53], s50, v5
    v_cmp_le_u32 vcc, s51, v5
    s_waitcnt vmcnt(2)
    v_lshl_or_b32 v56, v24, 16, v16
    v_and_or_b32 v58, v24, s47, v17
    v_lshl_or_b32 v60, v25, 16, v18
    v_and_or_b32 v62, v25, s47, v19
    ds_write_b32 v32, v56
    ds_write_b32 v33, v58
    ds_write_b32 v34, v60
    ds_write_b32 v35, v62
    s_waitcnt vmcnt(0)
    v_lshl_or_b32 v64, v26, 16, v20
    v_and_or_b32 v66, v26, s47, v21
    v_lshl_or_b32 v68, v27, 16, v22
    v_and_or_b32 v70, v27, s47, v23
    ds_write_b32 v36, v64
    ds_write_b32 v37, v66
    ds_write_b32 v38, v68
    ds_write_b32 v39, v70
    s_cbranch_vccnz K1_OVF
K1_OVD:
    s_mov_b64 exec, 1
    v_mov_b32 v6, 0
    v_mov_b32 v5, 1
    ds_add_u32 v6, v5 offset:46244
    s_cmp_lg_u64 s[52:53], 0
    s_cbranch_scc1 K1_OVF
K1_OVE:
K1_SPIN:
    ds_read_b32 v5, v6 offset:46244
    s_waitcnt lgkmcnt(0)
    v_cmp_gt_u32 vcc, 8, v5
    s_cbranch_vccnz K1_SPIN
    ds_read_b32 v32, v6 offset:46424
    s_mov_b64 exec, -1
    ds_read_b32 v24, v28 offset:164
    ds_read2_b32 v[10:11], v72 offset0:2 offset1:3
    ds_read2_b32 v[8:9], v72 offset1:1
    ds_read_b32 v25, v28 offset:11684
    ds_read2_b32 v[14:15], v73 offset0:2 offset1:3
    ds_read2_b32 v[12:13], v73 offset1:1
    ds_read_b32 v26, v28 offset:23204
    ds_read2_b32 v[18:19], v74 offset0:2 offset1:3
    ds_read2_b32 v[16:17], v74 offset1:1
    ds_read_b32 v27, v28 offset:34724
    ds_read2_b32 v[22:23], v75 offset0:2 offset1:3
    ds_read2_b32 v[20:21], v75 offset1:1
    ds_read_b32 v33, v76 offset:164
    ds_read2_b32 v[36:37], v77 offset0:32 offset1:33
    ds_read2_b32 v[38:39], v77 offset0:34 offset1:35
    s_waitcnt lgkmcnt(15)
    v_readfirstlane_b32 s56, v32
    s_cmp_lg_u32 s56, 0
    s_cselect_b32 s57, 0x800000, 0
    s_waitcnt lgkmcnt(14)
    v_cmp_lt_i32 vcc, v31, v24
    v_min_u32 v24, s51, v24
    v_or_b32 v24, s57, v24
    s_waitcnt lgkmcnt(13)
    v_perm_b32 v11, v24, v11, s54
    s_mov_b64 exec, vcc
    s_waitcnt lgkmcnt(12)
    buffer_store_dwordx4 v[8:11], v30, s[36:39], s48 offen sc1
    s_mov_b64 exec, -1
    s_add_u32 s48, s48, 2564096
    s_waitcnt lgkmcnt(11)
    v_cmp_lt_i32 vcc, v31, v25
    v_min_u32 v25, s51, v25
    v_or_b32 v25, s57, v25
    s_waitcnt lgkmcnt(10)
    v_perm_b32 v15, v25, v15, s54
    s_mov_b64 exec, vcc
    s_waitcnt lgkmcnt(9)
    buffer_store_dwordx4 v[12:15], v30, s[36:39], s48 offen sc1
    s_mov_b64 exec, -1
    s_add_u32 s48, s48, 2564096
    s_waitcnt lgkmcnt(8)
    v_cmp_lt_i32 vcc, v31, v26
    v_min_u32 v26, s51, v26
    v_or_b32 v26, s57, v26
    s_waitcnt lgkmcnt(7)
    v_perm_b32 v19, v26, v19, s54
    s_mov_b64 exec, vcc
    s_waitcnt lgkmcnt(6)
    buffer_store_dwordx4 v[16:19], v30, s[36:39], s48 offen sc1
    s_mov_b64 exec, -1
    s_add_u32 s48, s48, 2564096
    s_waitcnt lgkmcnt(5)
    v_cmp_lt_i32 vcc, v31, v27
    v_min_u32 v27, s51, v27
    v_or_b32 v27, s57, v27
    s_waitcnt lgkmcnt(4)
    v_perm_b32 v23, v27, v23, s54
    s_mov_b64 exec, vcc
    s_waitcnt lgkmcnt(3)
    buffer_store_dwordx4 v[20:23], v30, s[36:39], s48 offen sc1
    s_mov_b64 exec, -1
    s_waitcnt lgkmcnt(2)
    v_cmp_lt_i32 vcc, v79, v33
    s_mov_b64 exec, vcc
    s_waitcnt lgkmcnt(0)
    buffer_store_dwordx4 v[36:39], v78, s[36:39], s55 offen sc1
    s_cmp_lg_u32 s56, 0
    s_cbranch_scc1 K1_OVC
K1_BEND:
    s_endpgm
K1_TABLE:
    v_and_b32 v6, 31, v2
    v_lshrrev_b32 v10, 5, v2
    v_bfe_u32 v4, v2, 1, 3
    v_xor_b32 v4, v4, v10
    v_lshlrev_b32 v4, 4, v4
    v_lshl_add_u32 v4, v6, 7, v4
    v_add_u32 v4, s41, v4
    v_xor_b32 v3, 32, v4
    v_xor_b32 v5, 64, v4
    v_xor_b32 v15, 96, v4
    s_lshl_b32 s43, s2, 1
    s_add_u32 s43, s43, s23
    v_bfe_u32 v8, v2, 2, 2
    v_lshl_add_u32 v8, v10, 3, v8
    v_lshlrev_b32 v8, 7, v8
    v_and_b32 v9, 3, v2
    v_lshl_add_u32 v8, v9, 3, v8
    v_and_b32 v9, 16, v2
    v_lshl_add_u32 v8, v9, 1, v8
    v_and_b32 v9, 8, v2
    v_lshlrev_b32 v9, 3, v9
    s_lshl_b32 s41, s40, 6
    v_xor_b32 v9, s41, v9
    v_add_u32 v8, v8, v9
    v_lshlrev_b32 v7, 10, v10
    v_lshl_add_u32 v7, v6, 2, v7
    s_lshl_b32 s42, s43, 13
    s_lshl_b32 s41, s40, 7
    s_add_u32 s42, s42, s41
    s_add_u32 s43, s42, 4096
    s_mov_b32 s36, s20
    s_and_b32 s37, s21, 0xffff
    s_mov_b32 s38, 0x310000
    s_mov_b32 s39, 0x20000
    v_mov_b32 v13, 0
    v_mov_b32 v14, 1
    v_mov_b32 v10, 0xbfb8aa3b
    v_mov_b32 v11, 0xbfb8aa3b
    s_mov_b32 s44, 0x80008000
    s_mov_b32 s48, 0x07060100
    s_mov_b32 s49, 0x07060302
    s_mov_b64 exec, 1
    s_waitcnt vmcnt(0)
    ds_add_u32 v13, v14 offset:46604
K1_TSP:
    ds_read_b32 v14, v13 offset:46604
    s_waitcnt lgkmcnt(0)
    v_cmp_gt_u32 vcc, 4, v14
    s_cbranch_vccnz K1_TSP
    s_mov_b64 exec, -1
    ds_read_b128 v[96:99], v4 offset:63232
    ds_read_b64_tr_b16 v[48:49], v8 offset:46848
    ds_read_b64_tr_b16 v[50:51], v8 offset:47360
    ds_read_b128 v[100:103], v3 offset:63232
    ds_read_b64_tr_b16 v[52:53], v8 offset:48896
    ds_read_b64_tr_b16 v[54:55], v8 offset:49408
    ds_read_b128 v[104:107], v5 offset:63232
    ds_read_b64_tr_b16 v[56:57], v8 offset:50944
    ds_read_b64_tr_b16 v[58:59], v8 offset:51456
    ds_read_b128 v[108:111], v15 offset:63232
    ds_read_b64_tr_b16 v[60:61], v8 offset:52992
    ds_read_b64_tr_b16 v[62:63], v8 offset:53504
    s_cmp_eq_u32 s2, 249
    s_cbranch_scc1 K1_WT
    s_waitcnt lgkmcnt(9)
    v_mfma_f32_32x32x16_bf16 v[16:31], v[96:99], v[48:51], 0
    ds_read_b64_tr_b16 v[64:65], v8 offset:55040
    ds_read_b64_tr_b16 v[66:67], v8 offset:55552
    s_waitcnt lgkmcnt(8)
    v_mfma_f32_32x32x16_bf16 v[16:31], v[100:103], v[52:55], v[16:31]
    ds_read_b64_tr_b16 v[68:69], v8 offset:57088
    ds_read_b64_tr_b16 v[70:71], v8 offset:57600
    s_waitcnt lgkmcnt(7)
    v_mfma_f32_32x32x16_bf16 v[16:31], v[104:107], v[56:59], v[16:31]
    ds_read_b64_tr_b16 v[72:73], v8 offset:59136
    ds_read_b64_tr_b16 v[74:75], v8 offset:59648
    s_waitcnt lgkmcnt(6)
    v_mfma_f32_32x32x16_bf16 v[16:31], v[108:111], v[60:63], v[16:31]
    ds_read_b64_tr_b16 v[76:77], v8 offset:61184
    ds_read_b64_tr_b16 v[78:79], v8 offset:61696
    s_waitcnt lgkmcnt(6)
    v_mfma_f32_32x32x16_bf16 v[32:47], v[96:99], v[64:67], 0
    s_waitcnt lgkmcnt(4)
    v_mfma_f32_32x32x16_bf16 v[32:47], v[100:103], v[68:71], v[32:47]
    s_nop 5
    v_mul_f32 v16, v10, v16
    v_mul_f32 v17, v10, v17
    v_mul_f32 v18, v10, v18
    v_mul_f32 v19, v10, v19
    v_mul_f32 v20, v10, v20
    v_mul_f32 v21, v10, v21
    v_mul_f32 v22, v10, v22
    v_mul_f32 v23, v10, v23
    s_waitcnt lgkmcnt(2)
    v_mfma_f32_32x32x16_bf16 v[32:47], v[104:107], v[72:75], v[32:47]
    v_mul_f32 v24, v10, v24
    v_mul_f32 v25, v10, v25
    v_mul_f32 v26, v10, v26
    v_mul_f32 v27, v10, v27
    v_mul_f32 v28, v10, v28
    v_mul_f32 v29, v10, v29
    v_mul_f32 v30, v10, v30
    v_mul_f32 v31, v10, v31
    s_waitcnt lgkmcnt(0)
    v_mfma_f32_32x32x16_bf16 v[32:47], v[108:111], v[76:79], v[32:47]
    v_exp_f32 v48, v16
    v_exp_f32 v49, v17
    v_max3_f32 v13, abs(v16), abs(v17), v13
    v_exp_f32 v50, v18
    v_exp_f32 v51, v19
    v_max3_f32 v13, abs(v18), abs(v19), v13
    v_exp_f32 v52, v20
    v_exp_f32 v53, v21
    v_max3_f32 v13, abs(v20), abs(v21), v13
    v_exp_f32 v54, v22
    v_exp_f32 v55, v23
    v_max3_f32 v13, abs(v22), abs(v23), v13
    v_exp_f32 v56, v24
    v_exp_f32 v57, v25
    v_max3_f32 v13, abs(v24), abs(v25), v13
    v_exp_f32 v58, v26
    v_exp_f32 v59, v27
    v_max3_f32 v13, abs(v26), abs(v27), v13
    v_exp_f32 v60, v28
    v_exp_f32 v61, v29
    v_max3_f32 v13, abs(v28), abs(v29), v13
    v_exp_f32 v62, v30
    v_exp_f32 v63, v31
    v_max3_f32 v13, abs(v30), abs(v31), v13
    v_cvt_pk_f16_f32 v112, v48, v49
    v_max_f32_e64 v12, abs(v32), abs(v33)
    v_min_f32_e64 v14, abs(v32), abs(v33)
    v_pk_sub_u16 v120, s44, v112
    v_cvt_pk_f16_f32 v113, v50, v51
    v_max3_f32 v12, abs(v34), abs(v35), v12
    v_min3_f32 v14, abs(v34), abs(v35), v14
    v_pk_sub_u16 v121, s44, v113
    v_cvt_pk_f16_f32 v114, v52, v53
    v_max3_f32 v12, abs(v36), abs(v37), v12
    v_min3_f32 v14, abs(v36), abs(v37), v14
    v_pk_sub_u16 v122, s44, v114
    v_cvt_pk_f16_f32 v115, v54, v55
    v_max3_f32 v12, abs(v38), abs(v39), v12
    v_min3_f32 v14, abs(v38), abs(v39), v14
    v_pk_sub_u16 v123, s44, v115
    v_cvt_pk_f16_f32 v116, v56, v57
    v_max3_f32 v12, abs(v40), abs(v41), v12
    v_min3_f32 v14, abs(v40), abs(v41), v14
    v_pk_sub_u16 v124, s44, v116
    v_cvt_pk_f16_f32 v117, v58, v59
    v_max3_f32 v12, abs(v42), abs(v43), v12
    v_min3_f32 v14, abs(v42), abs(v43), v14
    v_pk_sub_u16 v125, s44, v117
    v_cvt_pk_f16_f32 v118, v60, v61
    v_max3_f32 v12, abs(v44), abs(v45), v12
    v_min3_f32 v14, abs(v44), abs(v45), v14
    v_pk_sub_u16 v126, s44, v118
    v_cvt_pk_f16_f32 v119, v62, v63
    v_max3_f32 v12, abs(v46), abs(v47), v12
    v_min3_f32 v14, abs(v46), abs(v47), v14
    v_pk_sub_u16 v127, s44, v119
    v_cmp_ngt_f32 vcc, 0x53800000, v12
    s_mov_b64 s[50:51], vcc
    v_cmp_nge_f32 vcc, 0x41600000, v13
    s_or_b64 s[50:51], s[50:51], vcc
    v_cmp_nle_f32 vcc, 0x17800000, v14
    s_mov_b32 s58, 1
    s_or_b64 vcc, vcc, s[50:51]
    s_cbranch_scc1 K1_TSLOW
    v_mov_b32 v13, 0
    v_mov_b32 v12, s58
    s_mov_b64 exec, 1
    ds_add_rtn_u32 v9, v13, v12 offset:46784
    s_mov_b64 exec, -1
    s_lshl_b32 s59, s2, 3
    s_add_u32 s52, s20, 0x384400
    s_addc_u32 s53, s21, 0
    s_and_b32 s53, s53, 0xffff
    s_mov_b32 s54, 0x620
    s_mov_b32 s55, 0x20000
    v_add_u32_sdwa v64, v32, v120 dst_sel:DWORD dst_unused:UNUSED_PAD src0_sel:DWORD src1_sel:WORD_0
    v_add_u32_sdwa v65, v33, v120 dst_sel:DWORD dst_unused:UNUSED_PAD src0_sel:DWORD src1_sel:WORD_1
    v_add_u32_sdwa v66, v34, v121 dst_sel:DWORD dst_unused:UNUSED_PAD src0_sel:DWORD src1_sel:WORD_0
    v_add_u32_sdwa v67, v35, v121 dst_sel:DWORD dst_unused:UNUSED_PAD src0_sel:DWORD src1_sel:WORD_1
    v_perm_b32 v80, v64, v112, s48
    v_perm_b32 v81, v65, v112, s49
    v_perm_b32 v82, v66, v113, s48
    v_perm_b32 v83, v67, v113, s49
    s_waitcnt lgkmcnt(0)
    v_readfirstlane_b32 s57, v9
    s_add_u32 s57, s57, s58
    s_bitcmp1_b32 s57, 2
    s_cbranch_scc0 K1_TFDa
    s_lshr_b32 s57, s57, 8
    v_mov_b32 v12, s57
    s_mov_b64 exec, 1
    buffer_store_dword v12, v13, s[52:55], s59 offen sc1
    s_mov_b64 exec, -1
K1_TFDa:
    v_add_u32_sdwa v68, v36, v122 dst_sel:DWORD dst_unused:UNUSED_PAD src0_sel:DWORD src1_sel:WORD_0
    v_add_u32_sdwa v69, v37, v122 dst_sel:DWORD dst_unused:UNUSED_PAD src0_sel:DWORD src1_sel:WORD_1
    v_add_u32_sdwa v70, v38, v123 dst_sel:DWORD dst_unused:UNUSED_PAD src0_sel:DWORD src1_sel:WORD_0
    v_add_u32_sdwa v71, v39, v123 dst_sel:DWORD dst_unused:UNUSED_PAD src0_sel:DWORD src1_sel:WORD_1
    v_perm_b32 v84, v68, v114, s48
    v_perm_b32 v85, v69, v114, s49
    v_perm_b32 v86, v70, v115, s48
    v_perm_b32 v87, v71, v115, s49
    v_add_u32_sdwa v72, v40, v124 dst_sel:DWORD dst_unused:UNUSED_PAD src0_sel:DWORD src1_sel:WORD_0
    v_add_u32_sdwa v73, v41, v124 dst_sel:DWORD dst_unused:UNUSED_PAD src0_sel:DWORD src1_sel:WORD_1
    v_add_u32_sdwa v74, v42, v125 dst_sel:DWORD dst_unused:UNUSED_PAD src0_sel:DWORD src1_sel:WORD_0
    v_add_u32_sdwa v75, v43, v125 dst_sel:DWORD dst_unused:UNUSED_PAD src0_sel:DWORD src1_sel:WORD_1
    v_perm_b32 v88, v72, v116, s48
    v_perm_b32 v89, v73, v116, s49
    v_perm_b32 v90, v74, v117, s48
    v_perm_b32 v91, v75, v117, s49
    v_add_u32_sdwa v76, v44, v126 dst_sel:DWORD dst_unused:UNUSED_PAD src0_sel:DWORD src1_sel:WORD_0
    v_add_u32_sdwa v77, v45, v126 dst_sel:DWORD dst_unused:UNUSED_PAD src0_sel:DWORD src1_sel:WORD_1
    v_add_u32_sdwa v78, v46, v127 dst_sel:DWORD dst_unused:UNUSED_PAD src0_sel:DWORD src1_sel:WORD_0
    v_add_u32_sdwa v79, v47, v127 dst_sel:DWORD dst_unused:UNUSED_PAD src0_sel:DWORD src1_sel:WORD_1
    v_perm_b32 v92, v76, v118, s48
    v_perm_b32 v93, v77, v118, s49
    v_perm_b32 v94, v78, v119, s48
    v_perm_b32 v95, v79, v119, s49
K1_TW2:
    ds_read_b32 v14, v13 offset:46244
    s_waitcnt lgkmcnt(0)
    v_cmp_gt_u32 vcc, 3, v14
    s_cbranch_vccnz K1_TW2
    buffer_store_dword v80, v7, s[36:39], s42 offen offset:0 sc1
    buffer_store_dword v81, v7, s[36:39], s42 offen offset:256 sc1
    buffer_store_dword v82, v7, s[36:39], s42 offen offset:512 sc1
    buffer_store_dword v83, v7, s[36:39], s42 offen offset:768 sc1
    buffer_store_dword v84, v7, s[36:39], s42 offen offset:2048 sc1
    buffer_store_dword v85, v7, s[36:39], s42 offen offset:2304 sc1
    buffer_store_dword v86, v7, s[36:39], s42 offen offset:2560 sc1
    buffer_store_dword v87, v7, s[36:39], s42 offen offset:2816 sc1
    buffer_store_dword v88, v7, s[36:39], s43 offen offset:0 sc1
    buffer_store_dword v89, v7, s[36:39], s43 offen offset:256 sc1
    buffer_store_dword v90, v7, s[36:39], s43 offen offset:512 sc1
    buffer_store_dword v91, v7, s[36:39], s43 offen offset:768 sc1
    buffer_store_dword v92, v7, s[36:39], s43 offen offset:2048 sc1
    buffer_store_dword v93, v7, s[36:39], s43 offen offset:2304 sc1
    buffer_store_dword v94, v7, s[36:39], s43 offen offset:2560 sc1
    buffer_store_dword v95, v7, s[36:39], s43 offen offset:2816 sc1
K1_TFLAG:
    s_endpgm
K1_OVC:
    s_mul_i32 s48, s2, 25600
    s_add_u32 s48, s48, 0x18063f8
    s_mov_b64 exec, 1
    buffer_store_dword v32, v6, s[36:39], s48 offen sc1
    s_branch K1_BEND
K1_OVF:
    s_mov_b64 s[56:57], vcc
    s_lshl_b32 s58, s2, 7
    s_add_u32 s58, s58, 0xdfff10
    s_mul_i32 s59, s2, 25600
    s_add_u32 s59, s59, 0x1800000
    s_mov_b64 exec, s[44:45]
    v_cmp_le_u32 s[60:61], s50, v40
    v_cmp_le_u32 s[62:63], s50, v41
    v_cmp_le_u32 s[64:65], s50, v42
    v_cmp_le_u32 s[66:67], s50, v43
    v_cmp_le_u32 s[68:69], s50, v44
    v_cmp_le_u32 s[70:71], s50, v45
    v_cmp_le_u32 s[72:73], s50, v46
    v_cmp_le_u32 s[74:75], s50, v47
    s_mov_b64 exec, s[60:61]
    s_cbranch_execz K1_L2S0
    v_lshrrev_b32 v5, 24, v8
    v_lshl_add_u32 v6, v40, 1, v40
    v_lshl_or_b32 v57, v5, 16, v48
    v_mul_u32_u24 v5, 40064, v5
    v_lshrrev_b32 v6, 18, v6
    v_cmp_gt_u32 vcc, s51, v40
    v_lshl_add_u32 v6, v6, 3, v5
    s_andn2_b64 s[52:53], exec, vcc
    s_mov_b64 exec, vcc
    buffer_store_dwordx2 v[56:57], v6, s[36:39], s58 offen sc1
    s_mov_b64 exec, s[52:53]
    s_cbranch_execz K1_L2S0
    v_mov_b32 v6, 0
    v_mov_b32 v5, 1
    ds_add_rtn_u32 v6, v6, v5 offset:46424
    s_waitcnt lgkmcnt(0)
    v_lshlrev_b32 v6, 3, v6
    buffer_store_dwordx2 v[56:57], v6, s[36:39], s59 offen sc1
K1_L2S0:
    s_mov_b64 exec, s[62:63]
    s_cbranch_execz K1_L2S1
    v_lshrrev_b32 v5, 24, v9
    v_lshl_add_u32 v6, v41, 1, v41
    v_lshl_or_b32 v59, v5, 16, v49
    v_mul_u32_u24 v5, 40064, v5
    v_lshrrev_b32 v6, 18, v6
    v_cmp_gt_u32 vcc, s51, v41
    v_lshl_add_u32 v6, v6, 3, v5
    s_andn2_b64 s[52:53], exec, vcc
    s_mov_b64 exec, vcc
    buffer_store_dwordx2 v[58:59], v6, s[36:39], s58 offen sc1
    s_mov_b64 exec, s[52:53]
    s_cbranch_execz K1_L2S1
    v_mov_b32 v6, 0
    v_mov_b32 v5, 1
    ds_add_rtn_u32 v6, v6, v5 offset:46424
    s_waitcnt lgkmcnt(0)
    v_lshlrev_b32 v6, 3, v6
    buffer_store_dwordx2 v[58:59], v6, s[36:39], s59 offen sc1
K1_L2S1:
    s_mov_b64 exec, s[64:65]
    s_cbranch_execz K1_L2S2
    v_lshrrev_b32 v5, 24, v10
    v_lshl_add_u32 v6, v42, 1, v42
    v_lshl_or_b32 v61, v5, 16, v50
    v_mul_u32_u24 v5, 40064, v5
    v_lshrrev_b32 v6, 18, v6
    v_cmp_gt_u32 vcc, s51, v42
    v_lshl_add_u32 v6, v6, 3, v5
    s_andn2_b64 s[52:53], exec, vcc
    s_mov_b64 exec, vcc
    buffer_store_dwordx2 v[60:61], v6, s[36:39], s58 offen sc1
    s_mov_b64 exec, s[52:53]
    s_cbranch_execz K1_L2S2
    v_mov_b32 v6, 0
    v_mov_b32 v5, 1
    ds_add_rtn_u32 v6, v6, v5 offset:46424
    s_waitcnt lgkmcnt(0)
    v_lshlrev_b32 v6, 3, v6
    buffer_store_dwordx2 v[60:61], v6, s[36:39], s59 offen sc1
K1_L2S2:
    s_mov_b64 exec, s[66:67]
    s_cbranch_execz K1_L2S3
    v_lshrrev_b32 v5, 24, v11
    v_lshl_add_u32 v6, v43, 1, v43
    v_lshl_or_b32 v63, v5, 16, v51
    v_mul_u32_u24 v5, 40064, v5
    v_lshrrev_b32 v6, 18, v6
    v_cmp_gt_u32 vcc, s51, v43
    v_lshl_add_u32 v6, v6, 3, v5
    s_andn2_b64 s[52:53], exec, vcc
    s_mov_b64 exec, vcc
    buffer_store_dwordx2 v[62:63], v6, s[36:39], s58 offen sc1
    s_mov_b64 exec, s[52:53]
    s_cbranch_execz K1_L2S3
    v_mov_b32 v6, 0
    v_mov_b32 v5, 1
    ds_add_rtn_u32 v6, v6, v5 offset:46424
    s_waitcnt lgkmcnt(0)
    v_lshlrev_b32 v6, 3, v6
    buffer_store_dwordx2 v[62:63], v6, s[36:39], s59 offen sc1
K1_L2S3:
    s_mov_b64 exec, s[68:69]
    s_cbranch_execz K1_L2S4
    v_lshrrev_b32 v5, 24, v12
    v_lshl_add_u32 v6, v44, 1, v44
    v_lshl_or_b32 v65, v5, 16, v52
    v_mul_u32_u24 v5, 40064, v5
    v_lshrrev_b32 v6, 18, v6
    v_cmp_gt_u32 vcc, s51, v44
    v_lshl_add_u32 v6, v6, 3, v5
    s_andn2_b64 s[52:53], exec, vcc
    s_mov_b64 exec, vcc
    buffer_store_dwordx2 v[64:65], v6, s[36:39], s58 offen sc1
    s_mov_b64 exec, s[52:53]
    s_cbranch_execz K1_L2S4
    v_mov_b32 v6, 0
    v_mov_b32 v5, 1
    ds_add_rtn_u32 v6, v6, v5 offset:46424
    s_waitcnt lgkmcnt(0)
    v_lshlrev_b32 v6, 3, v6
    buffer_store_dwordx2 v[64:65], v6, s[36:39], s59 offen sc1
K1_L2S4:
    s_mov_b64 exec, s[70:71]
    s_cbranch_execz K1_L2S5
    v_lshrrev_b32 v5, 24, v13
    v_lshl_add_u32 v6, v45, 1, v45
    v_lshl_or_b32 v67, v5, 16, v53
    v_mul_u32_u24 v5, 40064, v5
    v_lshrrev_b32 v6, 18, v6
    v_cmp_gt_u32 vcc, s51, v45
    v_lshl_add_u32 v6, v6, 3, v5
    s_andn2_b64 s[52:53], exec, vcc
    s_mov_b64 exec, vcc
    buffer_store_dwordx2 v[66:67], v6, s[36:39], s58 offen sc1
    s_mov_b64 exec, s[52:53]
    s_cbranch_execz K1_L2S5
    v_mov_b32 v6, 0
    v_mov_b32 v5, 1
    ds_add_rtn_u32 v6, v6, v5 offset:46424
    s_waitcnt lgkmcnt(0)
    v_lshlrev_b32 v6, 3, v6
    buffer_store_dwordx2 v[66:67], v6, s[36:39], s59 offen sc1
K1_L2S5:
    s_mov_b64 exec, s[72:73]
    s_cbranch_execz K1_L2S6
    v_lshrrev_b32 v5, 24, v14
    v_lshl_add_u32 v6, v46, 1, v46
    v_lshl_or_b32 v69, v5, 16, v54
    v_mul_u32_u24 v5, 40064, v5
    v_lshrrev_b32 v6, 18, v6
    v_cmp_gt_u32 vcc, s51, v46
    v_lshl_add_u32 v6, v6, 3, v5
    s_andn2_b64 s[52:53], exec, vcc
    s_mov_b64 exec, vcc
    buffer_store_dwordx2 v[68:69], v6, s[36:39], s58 offen sc1
    s_mov_b64 exec, s[52:53]
    s_cbranch_execz K1_L2S6
    v_mov_b32 v6, 0
    v_mov_b32 v5, 1
    ds_add_rtn_u32 v6, v6, v5 offset:46424
    s_waitcnt lgkmcnt(0)
    v_lshlrev_b32 v6, 3, v6
    buffer_store_dwordx2 v[68:69], v6, s[36:39], s59 offen sc1
K1_L2S6:
    s_mov_b64 exec, s[74:75]
    s_cbranch_execz K1_L2S7
    v_lshrrev_b32 v5, 24, v15
    v_lshl_add_u32 v6, v47, 1, v47
    v_lshl_or_b32 v71, v5, 16, v55
    v_mul_u32_u24 v5, 40064, v5
    v_lshrrev_b32 v6, 18, v6
    v_cmp_gt_u32 vcc, s51, v47
    v_lshl_add_u32 v6, v6, 3, v5
    s_andn2_b64 s[52:53], exec, vcc
    s_mov_b64 exec, vcc
    buffer_store_dwordx2 v[70:71], v6, s[36:39], s58 offen sc1
    s_mov_b64 exec, s[52:53]
    s_cbranch_execz K1_L2S7
    v_mov_b32 v6, 0
    v_mov_b32 v5, 1
    ds_add_rtn_u32 v6, v6, v5 offset:46424
    s_waitcnt lgkmcnt(0)
    v_lshlrev_b32 v6, 3, v6
    buffer_store_dwordx2 v[70:71], v6, s[36:39], s59 offen sc1
K1_L2S7:
    s_mov_b64 s[52:53], 0
    s_mov_b64 exec, 1
    v_mov_b32 v6, 0
    s_cmp_lg_u64 s[56:57], 0
    s_cbranch_scc1 K1_OVD
    s_branch K1_OVE
K1_TSLOW:
    s_mov_b32 s45, 0x7fffffff
    s_mov_b32 s46, 0x80000000
    s_mov_b32 s47, 0x7fff0000
    v_mov_b32 v10, 0x7f7f0000
    v_mov_b32 v11, 0xff7f0000
    v_mov_b32 v14, -1
    v_lshl_add_u32 v64, v32, 1, -1
    v_lshl_add_u32 v65, v33, 1, -1
    v_min3_u32 v14, v64, v65, v14
    v_lshl_add_u32 v66, v34, 1, -1
    v_lshl_add_u32 v67, v35, 1, -1
    v_min3_u32 v14, v66, v67, v14
    v_lshl_add_u32 v68, v36, 1, -1
    v_lshl_add_u32 v69, v37, 1, -1
    v_min3_u32 v14, v68, v69, v14
    v_lshl_add_u32 v70, v38, 1, -1
    v_lshl_add_u32 v71, v39, 1, -1
    v_min3_u32 v14, v70, v71, v14
    v_lshl_add_u32 v72, v40, 1, -1
    v_lshl_add_u32 v73, v41, 1, -1
    v_min3_u32 v14, v72, v73, v14
    v_lshl_add_u32 v74, v42, 1, -1
    v_lshl_add_u32 v75, v43, 1, -1
    v_min3_u32 v14, v74, v75, v14
    v_lshl_add_u32 v76, v44, 1, -1
    v_lshl_add_u32 v77, v45, 1, -1
    v_min3_u32 v14, v76, v77, v14
    v_lshl_add_u32 v78, v46, 1, -1
    v_lshl_add_u32 v79, v47, 1, -1
    v_min3_u32 v14, v78, v79, v14
    v_cmp_gt_u32 vcc, 0x2f000000, v14
    s_or_b64 vcc, vcc, s[50:51]
    s_cselect_b32 s58, 0x101, 1
    v_mov_b32 v13, 0
    v_mov_b32 v12, s58
    s_mov_b64 exec, 1
    ds_add_rtn_u32 v9, v13, v12 offset:46784
    s_mov_b64 exec, -1
    s_lshl_b32 s59, s2, 3
    s_add_u32 s52, s20, 0x384400
    s_addc_u32 s53, s21, 0
    s_and_b32 s53, s53, 0xffff
    s_mov_b32 s54, 0x620
    s_mov_b32 s55, 0x20000
    s_waitcnt lgkmcnt(0)
    v_readfirstlane_b32 s57, v9
    s_add_u32 s57, s57, s58
    s_bitcmp1_b32 s57, 2
    s_cbranch_scc0 K1_TFDb
    s_lshr_b32 s57, s57, 8
    v_mov_b32 v12, s57
    s_mov_b64 exec, 1
    buffer_store_dword v12, v13, s[52:55], s59 offen sc1
    s_mov_b64 exec, -1
K1_TFDb:
    v_mov_b32 v15, 0x41600000
    v_mul_f32_e64 v64, abs(v16), 0.5
    v_mul_f32 v64, 0.5, v64
    v_cvt_f16_f32 v64, v64
    v_and_b32 v64, 0x3fff, v64
    v_lshrrev_b32 v3, 17, v16
    v_and_b32 v3, 0x4000, v3
    v_or_b32 v64, v64, v3
    v_or_b32 v64, 0x8000, v64
    v_bfe_u32 v48, v112, 0, 16
    v_cmp_le_f32_e64 vcc, abs(v16), v15
    s_nop 1
    v_cndmask_b32 v64, v64, v48, vcc
    v_med3_f32 v32, v32, v10, v11
    v_and_b32 v4, s45, v32
    v_add_u32 v4, 0x8000, v4
    v_sub_u32 v4, v4, v64 clamp
    v_and_or_b32 v5, v32, s46, v64
    v_bfi_b32 v80, s47, v4, v5
    v_mul_f32_e64 v65, abs(v17), 0.5
    v_mul_f32 v65, 0.5, v65
    v_cvt_f16_f32 v65, v65
    v_and_b32 v65, 0x3fff, v65
    v_lshrrev_b32 v3, 17, v17
    v_and_b32 v3, 0x4000, v3
    v_or_b32 v65, v65, v3
    v_or_b32 v65, 0x8000, v65
    v_bfe_u32 v49, v112, 16, 16
    v_cmp_le_f32_e64 vcc, abs(v17), v15
    s_nop 1
    v_cndmask_b32 v65, v65, v49, vcc
    v_med3_f32 v33, v33, v10, v11
    v_and_b32 v4, s45, v33
    v_add_u32 v4, 0x8000, v4
    v_sub_u32 v4, v4, v65 clamp
    v_and_or_b32 v5, v33, s46, v65
    v_bfi_b32 v81, s47, v4, v5
    v_mul_f32_e64 v66, abs(v18), 0.5
    v_mul_f32 v66, 0.5, v66
    v_cvt_f16_f32 v66, v66
    v_and_b32 v66, 0x3fff, v66
    v_lshrrev_b32 v3, 17, v18
    v_and_b32 v3, 0x4000, v3
    v_or_b32 v66, v66, v3
    v_or_b32 v66, 0x8000, v66
    v_bfe_u32 v50, v113, 0, 16
    v_cmp_le_f32_e64 vcc, abs(v18), v15
    s_nop 1
    v_cndmask_b32 v66, v66, v50, vcc
    v_med3_f32 v34, v34, v10, v11
    v_and_b32 v4, s45, v34
    v_add_u32 v4, 0x8000, v4
    v_sub_u32 v4, v4, v66 clamp
    v_and_or_b32 v5, v34, s46, v66
    v_bfi_b32 v82, s47, v4, v5
    v_mul_f32_e64 v67, abs(v19), 0.5
    v_mul_f32 v67, 0.5, v67
    v_cvt_f16_f32 v67, v67
    v_and_b32 v67, 0x3fff, v67
    v_lshrrev_b32 v3, 17, v19
    v_and_b32 v3, 0x4000, v3
    v_or_b32 v67, v67, v3
    v_or_b32 v67, 0x8000, v67
    v_bfe_u32 v51, v113, 16, 16
    v_cmp_le_f32_e64 vcc, abs(v19), v15
    s_nop 1
    v_cndmask_b32 v67, v67, v51, vcc
    v_med3_f32 v35, v35, v10, v11
    v_and_b32 v4, s45, v35
    v_add_u32 v4, 0x8000, v4
    v_sub_u32 v4, v4, v67 clamp
    v_and_or_b32 v5, v35, s46, v67
    v_bfi_b32 v83, s47, v4, v5
    v_mul_f32_e64 v68, abs(v20), 0.5
    v_mul_f32 v68, 0.5, v68
    v_cvt_f16_f32 v68, v68
    v_and_b32 v68, 0x3fff, v68
    v_lshrrev_b32 v3, 17, v20
    v_and_b32 v3, 0x4000, v3
    v_or_b32 v68, v68, v3
    v_or_b32 v68, 0x8000, v68
    v_bfe_u32 v52, v114, 0, 16
    v_cmp_le_f32_e64 vcc, abs(v20), v15
    s_nop 1
    v_cndmask_b32 v68, v68, v52, vcc
    v_med3_f32 v36, v36, v10, v11
    v_and_b32 v4, s45, v36
    v_add_u32 v4, 0x8000, v4
    v_sub_u32 v4, v4, v68 clamp
    v_and_or_b32 v5, v36, s46, v68
    v_bfi_b32 v84, s47, v4, v5
    v_mul_f32_e64 v69, abs(v21), 0.5
    v_mul_f32 v69, 0.5, v69
    v_cvt_f16_f32 v69, v69
    v_and_b32 v69, 0x3fff, v69
    v_lshrrev_b32 v3, 17, v21
    v_and_b32 v3, 0x4000, v3
    v_or_b32 v69, v69, v3
    v_or_b32 v69, 0x8000, v69
    v_bfe_u32 v53, v114, 16, 16
    v_cmp_le_f32_e64 vcc, abs(v21), v15
    s_nop 1
    v_cndmask_b32 v69, v69, v53, vcc
    v_med3_f32 v37, v37, v10, v11
    v_and_b32 v4, s45, v37
    v_add_u32 v4, 0x8000, v4
    v_sub_u32 v4, v4, v69 clamp
    v_and_or_b32 v5, v37, s46, v69
    v_bfi_b32 v85, s47, v4, v5
    v_mul_f32_e64 v70, abs(v22), 0.5
    v_mul_f32 v70, 0.5, v70
    v_cvt_f16_f32 v70, v70
    v_and_b32 v70, 0x3fff, v70
    v_lshrrev_b32 v3, 17, v22
    v_and_b32 v3, 0x4000, v3
    v_or_b32 v70, v70, v3
    v_or_b32 v70, 0x8000, v70
    v_bfe_u32 v54, v115, 0, 16
    v_cmp_le_f32_e64 vcc, abs(v22), v15
    s_nop 1
    v_cndmask_b32 v70, v70, v54, vcc
    v_med3_f32 v38, v38, v10, v11
    v_and_b32 v4, s45, v38
    v_add_u32 v4, 0x8000, v4
    v_sub_u32 v4, v4, v70 clamp
    v_and_or_b32 v5, v38, s46, v70
    v_bfi_b32 v86, s47, v4, v5
    v_mul_f32_e64 v71, abs(v23), 0.5
    v_mul_f32 v71, 0.5, v71
    v_cvt_f16_f32 v71, v71
    v_and_b32 v71, 0x3fff, v71
    v_lshrrev_b32 v3, 17, v23
    v_and_b32 v3, 0x4000, v3
    v_or_b32 v71, v71, v3
    v_or_b32 v71, 0x8000, v71
    v_bfe_u32 v55, v115, 16, 16
    v_cmp_le_f32_e64 vcc, abs(v23), v15
    s_nop 1
    v_cndmask_b32 v71, v71, v55, vcc
    v_med3_f32 v39, v39, v10, v11
    v_and_b32 v4, s45, v39
    v_add_u32 v4, 0x8000, v4
    v_sub_u32 v4, v4, v71 clamp
    v_and_or_b32 v5, v39, s46, v71
    v_bfi_b32 v87, s47, v4, v5
    v_mul_f32_e64 v72, abs(v24), 0.5
    v_mul_f32 v72, 0.5, v72
    v_cvt_f16_f32 v72, v72
    v_and_b32 v72, 0x3fff, v72
    v_lshrrev_b32 v3, 17, v24
    v_and_b32 v3, 0x4000, v3
    v_or_b32 v72, v72, v3
    v_or_b32 v72, 0x8000, v72
    v_bfe_u32 v56, v116, 0, 16
    v_cmp_le_f32_e64 vcc, abs(v24), v15
    s_nop 1
    v_cndmask_b32 v72, v72, v56, vcc
    v_med3_f32 v40, v40, v10, v11
    v_and_b32 v4, s45, v40
    v_add_u32 v4, 0x8000, v4
    v_sub_u32 v4, v4, v72 clamp
    v_and_or_b32 v5, v40, s46, v72
    v_bfi_b32 v88, s47, v4, v5
    v_mul_f32_e64 v73, abs(v25), 0.5
    v_mul_f32 v73, 0.5, v73
    v_cvt_f16_f32 v73, v73
    v_and_b32 v73, 0x3fff, v73
    v_lshrrev_b32 v3, 17, v25
    v_and_b32 v3, 0x4000, v3
    v_or_b32 v73, v73, v3
    v_or_b32 v73, 0x8000, v73
    v_bfe_u32 v57, v116, 16, 16
    v_cmp_le_f32_e64 vcc, abs(v25), v15
    s_nop 1
    v_cndmask_b32 v73, v73, v57, vcc
    v_med3_f32 v41, v41, v10, v11
    v_and_b32 v4, s45, v41
    v_add_u32 v4, 0x8000, v4
    v_sub_u32 v4, v4, v73 clamp
    v_and_or_b32 v5, v41, s46, v73
    v_bfi_b32 v89, s47, v4, v5
    v_mul_f32_e64 v74, abs(v26), 0.5
    v_mul_f32 v74, 0.5, v74
    v_cvt_f16_f32 v74, v74
    v_and_b32 v74, 0x3fff, v74
    v_lshrrev_b32 v3, 17, v26
    v_and_b32 v3, 0x4000, v3
    v_or_b32 v74, v74, v3
    v_or_b32 v74, 0x8000, v74
    v_bfe_u32 v58, v117, 0, 16
    v_cmp_le_f32_e64 vcc, abs(v26), v15
    s_nop 1
    v_cndmask_b32 v74, v74, v58, vcc
    v_med3_f32 v42, v42, v10, v11
    v_and_b32 v4, s45, v42
    v_add_u32 v4, 0x8000, v4
    v_sub_u32 v4, v4, v74 clamp
    v_and_or_b32 v5, v42, s46, v74
    v_bfi_b32 v90, s47, v4, v5
    v_mul_f32_e64 v75, abs(v27), 0.5
    v_mul_f32 v75, 0.5, v75
    v_cvt_f16_f32 v75, v75
    v_and_b32 v75, 0x3fff, v75
    v_lshrrev_b32 v3, 17, v27
    v_and_b32 v3, 0x4000, v3
    v_or_b32 v75, v75, v3
    v_or_b32 v75, 0x8000, v75
    v_bfe_u32 v59, v117, 16, 16
    v_cmp_le_f32_e64 vcc, abs(v27), v15
    s_nop 1
    v_cndmask_b32 v75, v75, v59, vcc
    v_med3_f32 v43, v43, v10, v11
    v_and_b32 v4, s45, v43
    v_add_u32 v4, 0x8000, v4
    v_sub_u32 v4, v4, v75 clamp
    v_and_or_b32 v5, v43, s46, v75
    v_bfi_b32 v91, s47, v4, v5
    v_mul_f32_e64 v76, abs(v28), 0.5
    v_mul_f32 v76, 0.5, v76
    v_cvt_f16_f32 v76, v76
    v_and_b32 v76, 0x3fff, v76
    v_lshrrev_b32 v3, 17, v28
    v_and_b32 v3, 0x4000, v3
    v_or_b32 v76, v76, v3
    v_or_b32 v76, 0x8000, v76
    v_bfe_u32 v60, v118, 0, 16
    v_cmp_le_f32_e64 vcc, abs(v28), v15
    s_nop 1
    v_cndmask_b32 v76, v76, v60, vcc
    v_med3_f32 v44, v44, v10, v11
    v_and_b32 v4, s45, v44
    v_add_u32 v4, 0x8000, v4
    v_sub_u32 v4, v4, v76 clamp
    v_and_or_b32 v5, v44, s46, v76
    v_bfi_b32 v92, s47, v4, v5
    v_mul_f32_e64 v77, abs(v29), 0.5
    v_mul_f32 v77, 0.5, v77
    v_cvt_f16_f32 v77, v77
    v_and_b32 v77, 0x3fff, v77
    v_lshrrev_b32 v3, 17, v29
    v_and_b32 v3, 0x4000, v3
    v_or_b32 v77, v77, v3
    v_or_b32 v77, 0x8000, v77
    v_bfe_u32 v61, v118, 16, 16
    v_cmp_le_f32_e64 vcc, abs(v29), v15
    s_nop 1
    v_cndmask_b32 v77, v77, v61, vcc
    v_med3_f32 v45, v45, v10, v11
    v_and_b32 v4, s45, v45
    v_add_u32 v4, 0x8000, v4
    v_sub_u32 v4, v4, v77 clamp
    v_and_or_b32 v5, v45, s46, v77
    v_bfi_b32 v93, s47, v4, v5
    v_mul_f32_e64 v78, abs(v30), 0.5
    v_mul_f32 v78, 0.5, v78
    v_cvt_f16_f32 v78, v78
    v_and_b32 v78, 0x3fff, v78
    v_lshrrev_b32 v3, 17, v30
    v_and_b32 v3, 0x4000, v3
    v_or_b32 v78, v78, v3
    v_or_b32 v78, 0x8000, v78
    v_bfe_u32 v62, v119, 0, 16
    v_cmp_le_f32_e64 vcc, abs(v30), v15
    s_nop 1
    v_cndmask_b32 v78, v78, v62, vcc
    v_med3_f32 v46, v46, v10, v11
    v_and_b32 v4, s45, v46
    v_add_u32 v4, 0x8000, v4
    v_sub_u32 v4, v4, v78 clamp
    v_and_or_b32 v5, v46, s46, v78
    v_bfi_b32 v94, s47, v4, v5
    v_mul_f32_e64 v79, abs(v31), 0.5
    v_mul_f32 v79, 0.5, v79
    v_cvt_f16_f32 v79, v79
    v_and_b32 v79, 0x3fff, v79
    v_lshrrev_b32 v3, 17, v31
    v_and_b32 v3, 0x4000, v3
    v_or_b32 v79, v79, v3
    v_or_b32 v79, 0x8000, v79
    v_bfe_u32 v63, v119, 16, 16
    v_cmp_le_f32_e64 vcc, abs(v31), v15
    s_nop 1
    v_cndmask_b32 v79, v79, v63, vcc
    v_med3_f32 v47, v47, v10, v11
    v_and_b32 v4, s45, v47
    v_add_u32 v4, 0x8000, v4
    v_sub_u32 v4, v4, v79 clamp
    v_and_or_b32 v5, v47, s46, v79
    v_bfi_b32 v95, s47, v4, v5
    buffer_store_dword v80, v7, s[36:39], s42 offen offset:0 sc1
    buffer_store_dword v81, v7, s[36:39], s42 offen offset:256 sc1
    buffer_store_dword v82, v7, s[36:39], s42 offen offset:512 sc1
    buffer_store_dword v83, v7, s[36:39], s42 offen offset:768 sc1
    buffer_store_dword v84, v7, s[36:39], s42 offen offset:2048 sc1
    buffer_store_dword v85, v7, s[36:39], s42 offen offset:2304 sc1
    buffer_store_dword v86, v7, s[36:39], s42 offen offset:2560 sc1
    buffer_store_dword v87, v7, s[36:39], s42 offen offset:2816 sc1
    buffer_store_dword v88, v7, s[36:39], s43 offen offset:0 sc1
    buffer_store_dword v89, v7, s[36:39], s43 offen offset:256 sc1
    buffer_store_dword v90, v7, s[36:39], s43 offen offset:512 sc1
    buffer_store_dword v91, v7, s[36:39], s43 offen offset:768 sc1
    buffer_store_dword v92, v7, s[36:39], s43 offen offset:2048 sc1
    buffer_store_dword v93, v7, s[36:39], s43 offen offset:2304 sc1
    buffer_store_dword v94, v7, s[36:39], s43 offen offset:2560 sc1
    buffer_store_dword v95, v7, s[36:39], s43 offen offset:2816 sc1
    s_branch K1_TFLAG
K1_SPEC:
    s_cmp_eq_u32 s2, 249
    s_cbranch_scc1 K1_TGO
    s_cmp_eq_u32 s2, 248
    s_cbranch_scc1 K1_COEF
    s_branch K1_CPF
K1_WT:
    s_cmp_lg_u32 s23, 0
    s_cbranch_scc1 K1_END
    s_waitcnt lgkmcnt(0)
    ds_read_b64_tr_b16 v[64:65], v8 offset:55040
    ds_read_b64_tr_b16 v[66:67], v8 offset:55552
    ds_read_b64_tr_b16 v[68:69], v8 offset:57088
    ds_read_b64_tr_b16 v[70:71], v8 offset:57600
    ds_read_b64_tr_b16 v[72:73], v8 offset:59136
    ds_read_b64_tr_b16 v[74:75], v8 offset:59648
    ds_read_b64_tr_b16 v[76:77], v8 offset:61184
    ds_read_b64_tr_b16 v[78:79], v8 offset:61696
    s_waitcnt lgkmcnt(0)
    s_add_u32 s36, s20, 0x380000
    s_addc_u32 s37, s21, 0
    s_and_b32 s37, s37, 0xffff
    s_mov_b32 s38, 0x4000
    s_mov_b32 s39, 0x20000
    v_lshlrev_b32 v7, 4, v2
    s_lshl_b32 s41, s40, 12
    s_add_u32 s42, s41, 8192
    buffer_store_dwordx4 v[48:51], v7, s[36:39], s41 offen offset:0 sc1
    buffer_store_dwordx4 v[52:55], v7, s[36:39], s41 offen offset:1024 sc1
    buffer_store_dwordx4 v[56:59], v7, s[36:39], s41 offen offset:2048 sc1
    buffer_store_dwordx4 v[60:63], v7, s[36:39], s41 offen offset:3072 sc1
    buffer_store_dwordx4 v[64:67], v7, s[36:39], s42 offen offset:0 sc1
    buffer_store_dwordx4 v[68:71], v7, s[36:39], s42 offen offset:1024 sc1
    buffer_store_dwordx4 v[72:75], v7, s[36:39], s42 offen offset:2048 sc1
    buffer_store_dwordx4 v[76:79], v7, s[36:39], s42 offen offset:3072 sc1
    s_endpgm
K1_COEF:
    s_cmp_lg_u32 s3, 8
    s_cbranch_scc1 K1_END
    v_and_b32 v6, 15, v0
    v_bfe_u32 v7, v0, 4, 2
    v_lshl_add_u32 v6, v6, 2, v7
    v_lshlrev_b32 v6, 1, v6
    v_add_u32 v6, 16384, v6
    v_mov_b32 v68, 0
    s_waitcnt lgkmcnt(0)
    global_load_short_d16_hi v68, v6, s[16:17]
    s_add_u32 s36, s20, 0x384000
    s_addc_u32 s37, s21, 0
    s_and_b32 s37, s37, 0xffff
    s_mov_b32 s38, 0xa48
    s_mov_b32 s39, 0x20000
    s_barrier
    s_waitcnt vmcnt(0)
    v_and_b32 v7, 0x7fffffff, v68
    s_nop 1
    v_max_u32_dpp v7, v7, v7 row_shr:1 row_mask:0xf bank_mask:0xf
    s_nop 1
    v_max_u32_dpp v7, v7, v7 row_shr:2 row_mask:0xf bank_mask:0xf
    s_nop 1
    v_max_u32_dpp v7, v7, v7 row_shr:4 row_mask:0xf bank_mask:0xf
    s_nop 1
    v_max_u32_dpp v7, v7, v7 row_shr:8 row_mask:0xf bank_mask:0xf
    s_nop 1
    v_max_u32_dpp v7, v7, v7 row_bcast:15 row_mask:0xa bank_mask:0xf
    s_nop 1
    v_max_u32_dpp v7, v7, v7 row_bcast:31 row_mask:0xc bank_mask:0xf
    s_nop 0
    v_readlane_b32 s51, v7, 63
    s_nop 1
    v_rcp_f32 v48, s51
    s_nop 0
    v_mul_f32 v48, 0x3f9fff97, v48
    v_min_f32 v48, 0x44800000, v48
    v_max_f32 v48, 0x39800000, v48
    s_nop 0
    v_readfirstlane_b32 s25, v48
    s_add_u32 s25, s25, 0x7fffff
    s_and_b32 s25, s25, 0x7f800000
    s_sub_u32 s26, 0x7f000000, s25
    s_or_b32 s25, s25, 0x80000000
    v_mul_f32 v80, s25, v68
    v_mul_f32 v81, v80, v80
    v_mul_f32 v82, v81, v80
    v_mul_f32 v83, v82, v80
    v_mul_f32 v84, v83, v80
    v_mul_f32 v85, v84, v80
    v_mul_f32 v80, 0x40800000, v80
    v_mul_f32 v81, 0x3fffefae, v81
    v_mul_f32 v82, 0x3f2a705a, v82
    v_mul_f32 v83, 0x3e2bb62e, v83
    v_mul_f32 v84, 0x3d0fdb32, v84
    v_mul_f32 v85, 0x3bab6802, v85
    v_cvt_pk_f16_f32 v40, v80, v81
    v_cvt_pk_f16_f32 v41, v82, v83
    v_cvt_pk_f16_f32 v42, v84, v85
    v_fma_mix_f32 v86, v40, -1.0, v81 op_sel:[1,0,0] op_sel_hi:[1,0,0]
    v_cvt_pk_f16_f32 v43, v81, v86
    v_mov_b32 v49, s26
    s_cmp_le_u32 s51, 0x44800000
    s_cbranch_scc1 K1_THOK
    v_mov_b32 v48, -1.0
K1_THOK:
    v_lshlrev_b32 v7, 4, v2
    buffer_store_dwordx4 v[40:43], v7, s[36:39], 0 offen sc1
    s_mov_b64 exec, 1
    s_movk_i32 s25, 2624
    buffer_store_dwordx2 v[48:49], v7, s[36:39], s25 offen sc1
K1_END:
    s_endpgm
K1_CPF:
    s_add_u32 s72, s72, egc_main_kernel-egc_bin_kernel-1024
    s_addc_u32 s73, s73, 0
    s_bfe_u32 s74, s2, 0x20003
    s_lshl_b32 s74, s74, 12
    s_add_u32 s72, s72, s74
    s_addc_u32 s73, s73, 0
    s_barrier
    global_load_dwordx4 v[124:127], v120, s[72:73]
    s_endpgm
.p2align 8
K1_CEND:
.globl egc_main_kernel
.p2align 12
.type egc_main_kernel,@function
egc_main_kernel:
    s_load_dwordx2 s[8:9], s[0:1], 72
    s_load_dwordx2 s[56:57], s[0:1], 0
    s_load_dwordx2 s[4:5], s[0:1], 48
    s_load_dwordx2 s[20:21], s[0:1], 56
    s_cmp_ge_u32 s2, 256
    s_cbranch_scc1 K2_END
    v_lshrrev_b32 v26, 6, v0
    v_and_b32 v1, 63, v0
    v_readfirstlane_b32 s3, v26
    s_mul_i32 s10, s2, 49
    s_mov_b32 s31, 0
    s_mov_b32 s51, 16
    s_mov_b32 s30, 0
    s_mov_b32 s55, 0
    s_cmp_ge_u32 s3, 4
    s_cselect_b32 s29, 1, 0
    s_cselect_b32 s48, 12, 4
    s_cselect_b32 s49, 4, 0
    s_sub_u32 s49, s3, s49
K2_SRC0:
    v_lshlrev_b32 v24, 4, v0
    s_mul_i32 s24, s2, 40064
    s_add_u32 s24, s24, 0x400000
    s_add_u32 s25, s24, 15616
    v_mov_b32 v35, 0
    v_cmp_le_u32 vcc, 48, v0
    v_bfe_u32 v100, v0, 2, 1
    v_and_b32 v101, 0x3f8, v0
    v_mul_u32_u24 v100, 3904, v100
    v_and_or_b32 v102, v24, 16, v100
    s_add_u32 s11, s24, 32000
    s_mov_b32 s6, 0x33333333
    s_mov_b32 s7, s6
    v_lshl_add_u32 v100, v101, 2, v102
    v_mov_b32 v72, 0
    v_mov_b32 v73, 0
    v_mov_b32 v74, 0
    v_mov_b32 v75, 0
    v_add_u32 v3, 88064, v24
    ds_write_b128 v3, v[72:75]
    s_mul_i32 s26, s29, 26200
    v_min_u32 v2, 49, v1
    v_mul_u32_u24 v2, 524, v2
    v_add_u32 v2, s26, v2
    ds_write_b32 v2, v72 offset:36100
    s_add_u32 s26, s3, s31
    s_add_u32 s26, s26, s31
    s_cmp_lg_u32 s26, 1
    s_cbranch_scc1 K2_NOINIT
    v_lshlrev_b32 v25, 2, v1
    v_mov_b32 v26, 12500
    ds_write_b32 v25, v72 offset:0
    ds_write_b32 v25, v72 offset:256
    ds_write_b32 v25, v72 offset:512
    v_add_u32 v25, 25676, v25
    ds_write_b32 v25, v26 offset:35584
    ds_write_b32 v25, v26 offset:61784
K2_NOINIT:
    s_sub_u32 s28, s3, 4
    s_cmp_lt_u32 s28, 4
    s_cbranch_scc1 K2_DMA
    s_waitcnt lgkmcnt(0)
    s_mov_b32 s16, s8
    s_and_b32 s17, s9, 0xffff
    s_mov_b32 s18, 0x1f00000
    s_mov_b32 s19, 0x20000
    s_cmp_lt_u32 s3, 4
    s_cbranch_scc0 K2_NDMB
    buffer_load_dwordx4 v[28:31], v24, s[16:19], s24 offen
    s_mov_b64 exec, vcc
    buffer_load_dwordx4 v[32:35], v24, s[16:19], s25 offen
    s_mov_b64 exec, s[6:7]
    buffer_load_dwordx4 v[108:111], v100, s[16:19], s11 offen
    s_mov_b64 exec, -1
K2_NDMB:
    s_barrier
    s_cmp_lt_u32 s3, 4
    s_cbranch_scc1 K2_NDMC
    buffer_load_dwordx4 v[28:31], v24, s[16:19], s24 offen
    s_mov_b64 exec, vcc
    buffer_load_dwordx4 v[32:35], v24, s[16:19], s25 offen
    s_mov_b64 exec, s[6:7]
    buffer_load_dwordx4 v[108:111], v100, s[16:19], s11 offen
    s_mov_b64 exec, -1
K2_NDMC:
    v_and_b32 v6, 15, v0
    v_lshlrev_b32 v6, 4, v6
    s_sub_u32 s11, 12500, s10
    s_min_u32 s11, s11, 49
    s_mov_b32 s12, s8
    s_and_b32 s13, s9, 0xffff
    s_or_b32 s13, s13, 0x1000000
    s_mov_b32 s14, 0x30d4
    s_mov_b32 s15, 0x20000
    s_mov_b32 s20, s20
    s_and_b32 s21, s21, 0xffff
    s_mov_b32 s22, 0x186a00
    s_mov_b32 s23, 0x20000
    s_mov_b64 s[6:7], 0
    s_mov_b64 s[52:53], 0
    s_mov_b64 s[58:59], 0
    s_mov_b32 s34, -1
    s_mov_b32 s50, 1
    v_and_b32 v25, 7, v0
    v_lshlrev_b32 v36, 2, v25
    v_mul_u32_u24 v39, 1368, v25
    v_add_u32 v37, 1, v36
    v_lshrrev_b32 v39, 9, v39
    v_add_u32 v38, 2, v36
    v_add_u32 v39, 32, v39
    s_cmp_lt_u32 s28, 4
    s_cbranch_scc0 K2_NSIG
    s_waitcnt vmcnt(3)
    v_mov_b32 v25, 0
    v_mov_b32 v26, 1
    s_mov_b64 exec, 1
    ds_add_u32 v25, v26 offset:24
    s_mov_b64 exec, -1
K2_NSIG:
    s_sub_u32 s28, s3, 8
    s_cmp_ge_u32 s28, 8
    s_cbranch_scc1 K2_NOMM
    s_lshl_b32 s38, 4, s31
    v_mov_b32 v25, 0
K2_SPD:
    ds_read_b32 v26, v25 offset:24
    s_waitcnt lgkmcnt(0)
    v_cmp_gt_u32 vcc, s38, v26
    s_cbranch_vccnz K2_SPD
    v_lshlrev_b32 v26, 4, v1
    s_lshr_b32 s26, s28, 1
    s_lshl_b32 s26, s26, 12
    s_add_u32 s26, s26, 129536
    v_add_u32 v26, s26, v26
    ds_read_b128 v[112:115], v26 offset:0
    ds_read_b128 v[116:119], v26 offset:1024
    ds_read_b128 v[120:123], v26 offset:2048
    ds_read_b128 v[124:127], v26 offset:3072
    v_and_b32 v24, 31, v0
    v_bfe_u32 v25, v0, 5, 1
    s_and_b32 s25, s28, 1
    s_lshl_b32 s26, s25, 12
    s_add_u32 s26, s26, 145920
    v_and_b32 v26, 7, v0
    v_xor_b32 v26, v26, v25
    v_lshlrev_b32 v26, 4, v26
    v_lshl_add_u32 v26, v24, 7, v26
    v_xor_b32 v64, 0, v26
    v_add_u32 v64, s26, v64
    ds_read_b128 v[48:51], v64
    v_xor_b32 v65, 32, v26
    v_add_u32 v65, s26, v65
    ds_read_b128 v[52:55], v65
    v_xor_b32 v66, 64, v26
    v_add_u32 v66, s26, v66
    ds_read_b128 v[56:59], v66
    v_xor_b32 v67, 96, v26
    v_add_u32 v67, s26, v67
    ds_read_b128 v[60:63], v67
    v_lshlrev_b32 v24, 2, v24
    v_lshl_add_u32 v24, v25, 10, v24
    s_lshl_b32 s25, s25, 13
    s_bfe_u32 s26, s28, 0x10001
    s_lshl_b32 s26, s26, 7
    s_add_u32 s25, s25, s26
    s_lshr_b32 s26, s28, 2
    s_lshl_b32 s26, s26, 14
    s_add_u32 s25, s25, s26
    s_add_u32 s25, s25, 2816
    v_add_u32 v24, s25, v24
    s_waitcnt lgkmcnt(0)
    v_mfma_f32_32x32x16_bf16 v[64:79], v[48:51], v[112:115], 0
    v_mfma_f32_32x32x16_bf16 v[64:79], v[52:55], v[116:119], v[64:79]
    v_mfma_f32_32x32x16_bf16 v[64:79], v[56:59], v[120:123], v[64:79]
    v_mfma_f32_32x32x16_bf16 v[64:79], v[60:63], v[124:127], v[64:79]
    s_cmp_ge_u32 s28, 4
    s_cbranch_scc1 K2_MMW
    s_mov_b32 s25, 0x3fb8aa3b
    s_mov_b32 s26, 0xbfb8aa3b
    s_cmp_lg_u32 s31, 0
    s_cselect_b32 s25, s26, s25
    s_nop 5
    v_mul_f32 v64, s25, v64
    v_mul_f32 v65, s25, v65
    v_mul_f32 v66, s25, v66
    v_mul_f32 v67, s25, v67
    v_mul_f32 v68, s25, v68
    v_mul_f32 v69, s25, v69
    v_mul_f32 v70, s25, v70
    v_mul_f32 v71, s25, v71
    v_mul_f32 v72, s25, v72
    v_mul_f32 v73, s25, v73
    v_mul_f32 v74, s25, v74
    v_mul_f32 v75, s25, v75
    v_mul_f32 v76, s25, v76
    v_mul_f32 v77, s25, v77
    v_mul_f32 v78, s25, v78
    v_mul_f32 v79, s25, v79
    s_cbranch_scc1 K2_MMW
    v_mov_b32 v25, 0
    v_max3_f32 v25, abs(v64), abs(v65), v25
    v_max3_f32 v25, abs(v66), abs(v67), v25
    v_max3_f32 v25, abs(v68), abs(v69), v25
    v_max3_f32 v25, abs(v70), abs(v71), v25
    v_max3_f32 v25, abs(v72), abs(v73), v25
    v_max3_f32 v25, abs(v74), abs(v75), v25
    v_max3_f32 v25, abs(v76), abs(v77), v25
    v_max3_f32 v25, abs(v78), abs(v79), v25
    v_add_f32 v64, 0x40000000, v64
    v_add_f32 v65, 0x40000000, v65
    v_add_f32 v66, 0x40000000, v66
    v_add_f32 v67, 0x40000000, v67
    v_add_f32 v68, 0x40000000, v68
    v_add_f32 v69, 0x40000000, v69
    v_add_f32 v70, 0x40000000, v70
    v_add_f32 v71, 0x40000000, v71
    v_add_f32 v72, 0x40000000, v72
    v_add_f32 v73, 0x40000000, v73
    v_add_f32 v74, 0x40000000, v74
    v_add_f32 v75, 0x40000000, v75
    v_add_f32 v76, 0x40000000, v76
    v_add_f32 v77, 0x40000000, v77
    v_add_f32 v78, 0x40000000, v78
    v_add_f32 v79, 0x40000000, v79
    v_exp_f32 v64, v64
    v_exp_f32 v65, v65
    v_exp_f32 v66, v66
    v_exp_f32 v67, v67
    v_exp_f32 v68, v68
    v_exp_f32 v69, v69
    v_exp_f32 v70, v70
    v_exp_f32 v71, v71
    v_exp_f32 v72, v72
    v_exp_f32 v73, v73
    v_exp_f32 v74, v74
    v_exp_f32 v75, v75
    v_exp_f32 v76, v76
    v_exp_f32 v77, v77
    v_exp_f32 v78, v78
    v_exp_f32 v79, v79
    v_mov_b32 v26, 0x41600000
    v_cmp_nle_f32 vcc, v25, v26
    s_and_saveexec_b64 s[32:33], vcc
    s_cbranch_execz K2_NOBAD1
    v_mov_b32 v26, 0
    v_mov_b32 v25, 1
    ds_write_b32 v26, v25 offset:0
K2_NOBAD1:
    s_mov_b64 exec, -1
K2_MMW:
    s_nop 7
    s_nop 3
    ds_write_b32 v24, v64 offset:0
    ds_write_b32 v24, v65 offset:256
    ds_write_b32 v24, v66 offset:512
    ds_write_b32 v24, v67 offset:768
    ds_write_b32 v24, v68 offset:2048
    ds_write_b32 v24, v69 offset:2304
    ds_write_b32 v24, v70 offset:2560
    ds_write_b32 v24, v71 offset:2816
    ds_write_b32 v24, v72 offset:4096
    ds_write_b32 v24, v73 offset:4352
    ds_write_b32 v24, v74 offset:4608
    ds_write_b32 v24, v75 offset:4864
    ds_write_b32 v24, v76 offset:6144
    ds_write_b32 v24, v77 offset:6400
    ds_write_b32 v24, v78 offset:6656
    ds_write_b32 v24, v79 offset:6912
    s_and_b32 s26, s28, 4
    v_mov_b32 v25, s26
    v_mov_b32 v26, 1
    s_mov_b64 exec, 1
    ds_add_u32 v25, v26 offset:28
    s_mov_b64 exec, -1
K2_NOMM:
    s_mov_b32 s26, 0x0c0c0703
    s_waitcnt vmcnt(1)
K2_ULR:
    v_perm_b32 v27, v35, v31, s26
    v_mov_b32 v25, 524
    v_mov_b32 v26, 1
    v_mov_b32_dpp v27, v27 quad_perm:[0,0,0,0] row_mask:0xf bank_mask:0xf
    s_mov_b64 s[74:75], 0
    s_mov_b64 s[78:79], 0
    v_mov_b32_dpp v27, v27 row_half_mirror row_mask:0xf bank_mask:0xa
    v_cmp_lt_u32_sdwa s[60:61], v36, v27 src0_sel:DWORD src1_sel:BYTE_0
    v_cmp_lt_u32_sdwa s[62:63], v37, v27 src0_sel:DWORD src1_sel:BYTE_0
    v_cmp_lt_u32_sdwa s[64:65], v38, v27 src0_sel:DWORD src1_sel:BYTE_0
    v_cmp_lt_u32_sdwa s[66:67], v36, v27 src0_sel:DWORD src1_sel:BYTE_1
    v_cmp_lt_u32_sdwa s[68:69], v37, v27 src0_sel:DWORD src1_sel:BYTE_1
    v_cmp_lt_u32_sdwa s[70:71], v38, v27 src0_sel:DWORD src1_sel:BYTE_1
    v_cmp_lt_u32_sdwa s[72:73], v39, v27 src0_sel:DWORD src1_sel:BYTE_0
    v_cmp_lt_u32_sdwa s[76:77], v39, v27 src0_sel:DWORD src1_sel:BYTE_1
    s_or_b64 s[32:33], s[72:73], s[76:77]
    s_cbranch_scc1 K2_R2L
K2_SORT:
    s_mul_i32 s26, s29, 0x323232
    s_add_u32 s30, s30, 1
    s_add_u32 s55, s55, s48
    v_add_u32 v31, s26, v31
    v_add_u32 v35, s26, v35
    v_mul_u32_u24_sdwa v52, v25, v31 dst_sel:DWORD dst_unused:UNUSED_PAD src0_sel:DWORD src1_sel:BYTE_0
    v_mul_u32_u24_sdwa v53, v25, v31 dst_sel:DWORD dst_unused:UNUSED_PAD src0_sel:DWORD src1_sel:BYTE_1
    v_mul_u32_u24_sdwa v54, v25, v31 dst_sel:DWORD dst_unused:UNUSED_PAD src0_sel:DWORD src1_sel:BYTE_2
    v_mul_u32_u24_sdwa v55, v25, v35 dst_sel:DWORD dst_unused:UNUSED_PAD src0_sel:DWORD src1_sel:BYTE_0
    v_mul_u32_u24_sdwa v56, v25, v35 dst_sel:DWORD dst_unused:UNUSED_PAD src0_sel:DWORD src1_sel:BYTE_1
    v_mul_u32_u24_sdwa v57, v25, v35 dst_sel:DWORD dst_unused:UNUSED_PAD src0_sel:DWORD src1_sel:BYTE_2
    s_mov_b64 exec, s[60:61]
    ds_add_rtn_u32 v58, v52, v26 offset:36100
    s_mov_b64 exec, s[62:63]
    ds_add_rtn_u32 v59, v53, v26 offset:36100
    s_mov_b64 exec, s[64:65]
    ds_add_rtn_u32 v60, v54, v26 offset:36100
    s_mov_b64 exec, s[66:67]
    ds_add_rtn_u32 v61, v55, v26 offset:36100
    s_mov_b64 exec, s[68:69]
    ds_add_rtn_u32 v62, v56, v26 offset:36100
    s_mov_b64 exec, s[70:71]
    ds_add_rtn_u32 v63, v57, v26 offset:36100
    s_mov_b64 exec, -1
    s_waitcnt lgkmcnt(5)
    s_mov_b64 exec, s[60:61]
    v_min_u32 v58, 128, v58
    v_lshl_add_u32 v52, v58, 2, v52
    ds_write_b32 v52, v28 offset:35584
    s_waitcnt lgkmcnt(5)
    s_mov_b64 exec, s[62:63]
    v_min_u32 v59, 128, v59
    v_lshl_add_u32 v53, v59, 2, v53
    ds_write_b32 v53, v29 offset:35584
    s_waitcnt lgkmcnt(5)
    s_mov_b64 exec, s[64:65]
    v_min_u32 v60, 128, v60
    v_lshl_add_u32 v54, v60, 2, v54
    ds_write_b32 v54, v30 offset:35584
    s_waitcnt lgkmcnt(5)
    s_mov_b64 exec, s[66:67]
    v_min_u32 v61, 128, v61
    v_lshl_add_u32 v55, v61, 2, v55
    ds_write_b32 v55, v32 offset:35584
    s_waitcnt lgkmcnt(5)
    s_mov_b64 exec, s[68:69]
    v_min_u32 v62, 128, v62
    v_lshl_add_u32 v56, v62, 2, v56
    ds_write_b32 v56, v33 offset:35584
    s_waitcnt lgkmcnt(5)
    s_mov_b64 exec, s[70:71]
    v_min_u32 v63, 128, v63
    v_lshl_add_u32 v57, v63, 2, v57
    ds_write_b32 v57, v34 offset:35584
    s_cmp_lt_i32 s51, 0
    s_cbranch_scc1 K2_SORT2
K2_L2SKIP:
    s_lshl_b32 s26, s29, 2
    s_mov_b64 exec, -1
    v_mov_b32 v25, s26
    s_mov_b64 exec, 1
    ds_add_u32 v25, v26 offset:16
    s_mov_b64 exec, -1
    s_mov_b32 s37, 128
    s_lshl_b32 s41, s3, 10
    s_add_u32 s41, s41, 88064
    s_mul_i32 s38, s48, 60
    s_movk_i32 s42, 16384
    s_cmp_eq_u32 s29, 0
    s_cselect_b32 s42, s42, 5462
K2_SPT:
    ds_read_b32 v26, v25 offset:16
    ds_read_b32 v28, v2 offset:36100
    s_waitcnt lgkmcnt(1)
    v_cmp_gt_u32 vcc, s55, v26
    s_cbranch_vccnz K2_SPT
    s_cmp_lt_u32 s3, 8
    s_cbranch_scc0 K2_PRA
    s_setprio 2
K2_PRA:
    s_cmp_lt_u32 s3, 12
    s_cbranch_scc1 K2_PRB
    s_setprio 1
K2_PRB:
    v_lshlrev_b32 v30, 16, v1
    s_waitcnt lgkmcnt(0)
K2_RESCAN:
    v_min_u32 v29, s37, v28
    v_add_u32 v5, 3, v29
    v_lshrrev_b32 v5, 2, v5
    v_mov_b32 v4, v5
    s_nop 1
    v_add_u32_dpp v4, v4, v4 row_shr:1 row_mask:0xf bank_mask:0xf
    s_nop 1
    v_add_u32_dpp v4, v4, v4 row_shr:2 row_mask:0xf bank_mask:0xf
    s_nop 1
    v_add_u32_dpp v4, v4, v4 row_shr:4 row_mask:0xf bank_mask:0xf
    s_nop 1
    v_add_u32_dpp v4, v4, v4 row_shr:8 row_mask:0xf bank_mask:0xf
    s_nop 1
    v_add_u32_dpp v4, v4, v4 row_bcast:15 row_mask:0xa bank_mask:0xf
    s_nop 1
    v_add_u32_dpp v4, v4, v4 row_bcast:31 row_mask:0xc bank_mask:0xf
    v_cmp_lt_u32 vcc, s37, v28
    v_readlane_b32 s39, v4, 63
    v_sub_u32 v4, v4, v5
    s_cmp_gt_u32 s39, s38
    s_cbranch_scc1 K2_LIMIT
    s_mov_b32 s35, 0
    s_cbranch_vccnz K2_PEND
K2_PDONE:
    s_add_u32 s40, s39, 3
    s_lshr_b32 s40, s40, 2
    s_mul_i32 s42, s42, s40
    s_lshr_b32 s42, s42, 16
    s_mul_i32 s43, s42, s48
    s_sub_u32 s43, s40, s43
    s_mul_i32 s44, s49, s42
    s_min_u32 s45, s49, s43
    s_add_u32 s44, s44, s45
    s_lshl_b32 s44, s44, 2
    s_cmp_lt_u32 s49, s43
    s_addc_u32 s40, s42, 0
    v_or_b32 v30, v30, v4
    v_subrev_u32 v24, s44, v4
    v_cmp_ge_u32 s[32:33], s44, v4
    v_cmp_ne_u32 s[26:27], 0, v5
    v_subrev_u32 v25, 1, v24
    v_cmp_gt_u32 vcc, 63, v25
    v_lshl_add_u32 v24, v24, 4, s41
    s_bitset1_b64 s[26:27], 49
    s_and_b64 exec, vcc, s[26:27]
    ds_write_b32 v24, v30 offset:12
    s_mov_b64 exec, -1
    ds_read_b32 v31, v3 offset:12
    s_and_b32 s33, s33, 0x3ffff
    s_bcnt1_i32_b64 s25, s[32:33]
    s_sub_u32 s25, s25, 1
    v_readlane_b32 s25, v30, s25
    v_lshlrev_b32 v25, 2, v5
    v_sub_u32 v25, v25, v29
    v_lshl_add_u32 v24, v29, 2, v2
    v_mov_b32 v26, 12500
    v_cmp_lt_u32 vcc, 0, v25
    s_mov_b64 exec, vcc
    ds_write_b32 v24, v26 offset:35584
    v_cmp_lt_u32 vcc, 1, v25
    s_mov_b64 exec, vcc
    ds_write_b32 v24, v26 offset:35588
    v_cmp_lt_u32 vcc, 2, v25
    s_mov_b64 exec, vcc
    ds_write_b32 v24, v26 offset:35592
    s_mov_b64 exec, -1
    s_lshl_b32 s45, s40, 4
    v_bfe_u32 v7, v0, 4, 2
    v_mul_u32_u24 v7, s45, v7
    v_add_u32 v7, s41, v7
    v_bfe_u32 v8, v0, 2, 2
    v_mul_u32_u24 v8, s45, v8
    v_and_b32 v25, 3, v0
    v_lshl_add_u32 v8, v25, 1, v8
    v_and_b32 v25, 48, v0
    v_add3_u32 v8, v8, v25, s41
    v_add_u32 v24, s44, v1
    s_mul_i32 s24, s29, 26200
    s_waitcnt lgkmcnt(3)
    v_cmp_ne_u32 s[46:47], 0, v31
    v_max_u32 v31, s25, v31
    s_nop 1
    v_max_u32_dpp v31, v31, v31 row_shr:1 row_mask:0xf bank_mask:0xf
    s_nop 1
    v_max_u32_dpp v31, v31, v31 row_shr:2 row_mask:0xf bank_mask:0xf
    s_nop 1
    v_max_u32_dpp v31, v31, v31 row_shr:4 row_mask:0xf bank_mask:0xf
    s_nop 1
    v_max_u32_dpp v31, v31, v31 row_shr:8 row_mask:0xf bank_mask:0xf
    s_nop 1
    v_max_u32_dpp v31, v31, v31 row_bcast:15 row_mask:0xa bank_mask:0xf
    s_nop 1
    v_max_u32_dpp v31, v31, v31 row_bcast:31 row_mask:0xc bank_mask:0xf
    v_and_b32 v25, 0xffff, v31
    v_lshrrev_b32 v31, 16, v31
    v_sub_u32 v24, v24, v25
    v_min_u32 v24, 31, v24
    v_mul_u32_u24 v25, 524, v31
    v_lshl_add_u32 v24, v24, 4, s24
    v_add_u32 v24, v24, v25
    v_lshl_or_b32 v32, v24, 16, v24
    v_lshlrev_b32 v34, 8, v31
    v_mov_b32 v35, 0
    v_add_u32 v33, 0xc0008, v32
    v_add_u32 v32, 0x40000, v32
    ds_write_b128 v3, v[32:35]
    ds_read_u16 v9, v7
    ds_read_u16 v24, v7 offset:16
    ds_read_u16 v19, v8
    ds_read_u16 v25, v7 offset:32
    ds_read_u16 v20, v7 offset:8
    s_lshl_b32 s25, s40, 1
    s_lshr_b64 s[26:27], s[46:47], s25
    s_or_b64 s[46:47], s[46:47], s[26:27]
    s_lshr_b64 s[26:27], s[46:47], s40
    s_or_b32 s46, s46, s26
    v_mov_b32 v27, 0
    v_mov_b32 v49, v6
    v_mov_b32 v51, v6
    v_mov_b32 v53, v6
    v_mov_b32 v55, v6
    s_waitcnt lgkmcnt(4)
    ds_read_u16 v28, v9 offset:35584
    ds_read_u16 v30, v9 offset:35588
    ds_read_u16 v32, v9 offset:35592
    ds_read_u16 v34, v9 offset:35596
    v_mov_b32 v29, v6
    v_mov_b32 v31, v6
    v_mov_b32 v33, v6
    v_mov_b32 v35, v6
    s_waitcnt lgkmcnt(7)
    ds_read_u16 v48, v24 offset:35584
    ds_read_u16 v50, v24 offset:35588
    ds_read_u16 v52, v24 offset:35592
    ds_read_u16 v54, v24 offset:35596
    s_waitcnt lgkmcnt(9)
    ds_read_u16_d16_hi v27, v19 offset:35586
    s_cmp_lt_u32 s40, 2
    s_cbranch_scc1 K2_NOG1
    s_waitcnt lgkmcnt(5)
    buffer_load_dwordx4 v[80:83], v[28:29], s[12:15], 0 idxen offen
    buffer_load_dwordx4 v[84:87], v[30:31], s[12:15], 0 idxen offen
    buffer_load_dwordx4 v[88:91], v[32:33], s[12:15], 0 idxen offen
    buffer_load_dwordx4 v[92:95], v[34:35], s[12:15], 0 idxen offen
    ds_read_u16 v28, v25 offset:35584
    ds_read_u16 v30, v25 offset:35588
    ds_read_u16 v32, v25 offset:35592
    ds_read_u16 v34, v25 offset:35596
    ds_read_u16 v9, v7 offset:48
    s_waitcnt lgkmcnt(6)
    buffer_load_dwordx4 v[96:99], v[48:49], s[12:15], 0 idxen offen
    buffer_load_dwordx4 v[100:103], v[50:51], s[12:15], 0 idxen offen
    buffer_load_dwordx4 v[104:107], v[52:53], s[12:15], 0 idxen offen
    buffer_load_dwordx4 v[108:111], v[54:55], s[12:15], 0 idxen offen
K2_G0D:
    s_sub_u32 s25, s3, 3
    s_cmp_lt_u32 s25, 2
    s_cbranch_scc1 K2_PUB
K2_PUBD:
    s_cmp_eq_u32 s50, 0
    s_cbranch_scc1 K2_NOMM2
    s_mov_b32 s50, 0
    s_lshl_b32 s38, 4, s31
    v_mov_b32 v56, 0
K2_SPP:
    ds_read_b32 v57, v56 offset:28
    s_waitcnt lgkmcnt(0)
    v_cmp_gt_u32 vcc, s38, v57
    s_cbranch_vccnz K2_SPP
    v_lshlrev_b32 v26, 4, v1
    s_cmp_lg_u32 s31, 0
    s_cbranch_scc1 K2_NOBC
    v_add_u32 v24, 104448, v26
    ds_read_b128 v[12:15], v24
K2_NOBC:
    s_cmp_lt_u32 s3, 12
    s_cbranch_scc1 K2_NOFL
    v_subrev_u32 v24, 768, v0
    v_lshlrev_b32 v25, 3, v24
    v_add_u32 v25, 105472, v25
    ds_read_b32 v76, v25
    v_cmp_gt_u32 vcc, 196, v24
    s_mov_b64 exec, vcc
    v_mov_b32 v24, 0
    v_mov_b32 v25, 1
    s_waitcnt lgkmcnt(0)
    v_cmp_ne_u32 vcc, 0, v76
    s_mov_b64 exec, vcc
    ds_write_b32 v24, v25 offset:0
    s_mov_b64 exec, -1
K2_NOFL:
    s_or_b64 s[32:33], s[72:73], s[76:77]
    s_cbranch_scc1 K2_LWR
K2_LWD:
K2_NOMM2:
    s_cmp_eq_u32 s40, 0
    s_cbranch_scc1 K2_MDONE
    v_mov_b32 v25, 104448
    ds_read_b64 v[10:11], v25 offset:2624
    s_mul_i32 s25, s29, 12800
    s_add_u32 s25, s25, 112640
    v_lshlrev_b32 v46, 4, v0
    v_add_u32 v46, s25, v46
    s_waitcnt lgkmcnt(0)
    v_readfirstlane_b32 s54, v10
    v_add_u32 v25, v20, v6
    v_add_u32 v45, v20, v46
    ds_read_b128 v[20:23], v25 offset:2816
    v_mov_b64 v[36:37], 0
    v_mov_b64 v[38:39], 0
    s_cmp_lg_u32 s31, 0
    s_cbranch_scc1 K2_MAIN_S
    v_mul_f32 v25, v11, v27
    v_cmp_nle_f32_e64 s[0:1], abs(v27), s54
    v_mul_f32 v26, v25, v25
    v_cvt_pk_f16_f32 v16, v25, v26
    v_pk_mul_f16 v17, v16, v16 op_sel:[0,1] op_sel_hi:[1,1]
    v_fma_mix_f32 v25, v16, -1.0, v26 op_sel:[1,0,0] op_sel_hi:[1,0,0]
    v_pk_mul_f16 v18, v17, v16 op_sel:[0,1] op_sel_hi:[1,1]
    v_cvt_pk_f16_f32 v19, v25, v26
    v_mfma_f32_16x16x4_4b_f16 v[48:63], v[16:17], v[12:13], 4.0 cbsz:2 abid:0
    s_nop 0
    v_mfma_f32_16x16x4_4b_f16 v[48:63], v[18:19], v[14:15], v[48:63] cbsz:2 abid:0
K2_IT0:
    s_cmp_le_u32 s40, 2
    s_cbranch_scc1 K2_TL0
    buffer_load_dwordx4 v[112:115], v[28:29], s[12:15], 0 idxen offen
    buffer_load_dwordx4 v[116:119], v[30:31], s[12:15], 0 idxen offen
    buffer_load_dwordx4 v[120:123], v[32:33], s[12:15], 0 idxen offen
    buffer_load_dwordx4 v[124:127], v[34:35], s[12:15], 0 idxen offen
K2_BD0:
    ds_read_u16 v28, v9 offset:35584
    ds_read_u16 v30, v9 offset:35588
    ds_read_u16 v32, v9 offset:35592
    ds_read_u16 v34, v9 offset:35596
    ds_read_u16 v9, v7 offset:64
    ds_read_u16 v44, v7 offset:24
    v_mfma_f32_16x16x4_4b_f16 v[64:79], v[16:17], v[12:13], 4.0 cbsz:2 abid:1
    s_waitcnt vmcnt(8) lgkmcnt(6)
    v_fma_mix_f32 v40, v80, v48, v20 op_sel_hi:[1,0,0]
    v_fma_mix_f32 v41, v81, v52, v21 op_sel_hi:[1,0,0]
    v_fma_mix_f32 v42, v84, v49, v20 op_sel_hi:[1,0,0]
    v_fma_mix_f32 v43, v85, v53, v21 op_sel_hi:[1,0,0]
    v_fma_mix_f32 v48, v88, v50, v20 op_sel_hi:[1,0,0]
    v_fma_mix_f32 v49, v89, v54, v21 op_sel_hi:[1,0,0]
    v_fma_mix_f32 v52, v92, v51, v20 op_sel_hi:[1,0,0]
    v_fma_mix_f32 v53, v93, v55, v21 op_sel_hi:[1,0,0]
    v_mfma_f32_16x16x4_4b_f16 v[64:79], v[18:19], v[14:15], v[64:79] cbsz:2 abid:1
    v_fma_mix_f32 v50, v82, v56, v22 op_sel_hi:[1,0,0]
    v_fma_mix_f32 v51, v83, v60, v23 op_sel_hi:[1,0,0]
    v_fma_mix_f32 v54, v86, v57, v22 op_sel_hi:[1,0,0]
    v_fma_mix_f32 v55, v87, v61, v23 op_sel_hi:[1,0,0]
    v_fma_mix_f32 v56, v90, v58, v22 op_sel_hi:[1,0,0]
    v_fma_mix_f32 v57, v91, v62, v23 op_sel_hi:[1,0,0]
    v_fma_mix_f32 v60, v94, v59, v22 op_sel_hi:[1,0,0]
    v_fma_mix_f32 v61, v95, v63, v23 op_sel_hi:[1,0,0]
    v_pk_mul_f32 v[80:81], v[80:81], v[42:43]
    v_pk_mul_f32 v[82:83], v[82:83], v[54:55]
    v_pk_mul_f32 v[88:89], v[88:89], v[52:53]
    v_pk_mul_f32 v[90:91], v[90:91], v[60:61]
    v_pk_fma_f32 v[80:81], v[84:85], v[40:41], v[80:81]
    v_pk_fma_f32 v[82:83], v[86:87], v[50:51], v[82:83]
    v_pk_fma_f32 v[88:89], v[92:93], v[48:49], v[88:89]
    v_pk_fma_f32 v[90:91], v[94:95], v[56:57], v[90:91]
    v_pk_mul_f32 v[40:41], v[40:41], v[42:43]
    v_pk_mul_f32 v[50:51], v[50:51], v[54:55]
    v_pk_mul_f32 v[48:49], v[48:49], v[52:53]
    v_pk_mul_f32 v[56:57], v[56:57], v[60:61]
    v_pk_mul_f32 v[42:43], v[40:41], v[48:49]
    v_pk_mul_f32 v[54:55], v[50:51], v[56:57]
    v_rcp_f32 v52, v42
    v_rcp_f32 v53, v43
    v_rcp_f32 v60, v54
    v_rcp_f32 v61, v55
    v_pk_mul_f32 v[80:81], v[80:81], v[48:49]
    v_pk_mul_f32 v[82:83], v[82:83], v[56:57]
    v_pk_fma_f32 v[80:81], v[88:89], v[40:41], v[80:81]
    v_pk_fma_f32 v[82:83], v[90:91], v[50:51], v[82:83]
    v_pk_fma_f32 v[36:37], v[80:81], v[52:53], v[36:37]
    v_pk_fma_f32 v[38:39], v[82:83], v[60:61], v[38:39]
K2_IT1:
    s_cmp_le_u32 s40, 3
    s_cbranch_scc1 K2_TL1
    s_waitcnt lgkmcnt(0)
    buffer_load_dwordx4 v[80:83], v[28:29], s[12:15], 0 idxen offen
    buffer_load_dwordx4 v[84:87], v[30:31], s[12:15], 0 idxen offen
    buffer_load_dwordx4 v[88:91], v[32:33], s[12:15], 0 idxen offen
    buffer_load_dwordx4 v[92:95], v[34:35], s[12:15], 0 idxen offen
K2_BD1:
    s_bitcmp1_b32 s46, 1
    s_cbranch_scc1 K2_FL1
K2_NF1:
    ds_read_u16 v28, v9 offset:35584
    ds_read_u16 v30, v9 offset:35588
    ds_read_u16 v32, v9 offset:35592
    ds_read_u16 v34, v9 offset:35596
    ds_read_u16 v9, v7 offset:80
    ds_read_u16 v44, v7 offset:40
    ds_read_u16 v10, v8 offset:64
    v_mfma_f32_16x16x4_4b_f16 v[48:63], v[16:17], v[12:13], 4.0 cbsz:2 abid:2
    s_waitcnt vmcnt(8) lgkmcnt(7)
    v_fma_mix_f32 v40, v96, v64, v20 op_sel_hi:[1,0,0]
    v_fma_mix_f32 v41, v97, v68, v21 op_sel_hi:[1,0,0]
    v_fma_mix_f32 v42, v100, v65, v20 op_sel_hi:[1,0,0]
    v_fma_mix_f32 v43, v101, v69, v21 op_sel_hi:[1,0,0]
    v_fma_mix_f32 v64, v104, v66, v20 op_sel_hi:[1,0,0]
    v_fma_mix_f32 v65, v105, v70, v21 op_sel_hi:[1,0,0]
    v_fma_mix_f32 v68, v108, v67, v20 op_sel_hi:[1,0,0]
    v_fma_mix_f32 v69, v109, v71, v21 op_sel_hi:[1,0,0]
    v_mfma_f32_16x16x4_4b_f16 v[48:63], v[18:19], v[14:15], v[48:63] cbsz:2 abid:2
    v_fma_mix_f32 v66, v98, v72, v22 op_sel_hi:[1,0,0]
    v_fma_mix_f32 v67, v99, v76, v23 op_sel_hi:[1,0,0]
    v_fma_mix_f32 v70, v102, v73, v22 op_sel_hi:[1,0,0]
    v_fma_mix_f32 v71, v103, v77, v23 op_sel_hi:[1,0,0]
    v_fma_mix_f32 v72, v106, v74, v22 op_sel_hi:[1,0,0]
    v_fma_mix_f32 v73, v107, v78, v23 op_sel_hi:[1,0,0]
    v_fma_mix_f32 v76, v110, v75, v22 op_sel_hi:[1,0,0]
    v_fma_mix_f32 v77, v111, v79, v23 op_sel_hi:[1,0,0]
    v_pk_mul_f32 v[96:97], v[96:97], v[42:43]
    v_pk_mul_f32 v[98:99], v[98:99], v[70:71]
    v_pk_mul_f32 v[104:105], v[104:105], v[68:69]
    v_pk_mul_f32 v[106:107], v[106:107], v[76:77]
    v_pk_fma_f32 v[96:97], v[100:101], v[40:41], v[96:97]
    v_pk_fma_f32 v[98:99], v[102:103], v[66:67], v[98:99]
    v_pk_fma_f32 v[104:105], v[108:109], v[64:65], v[104:105]
    v_pk_fma_f32 v[106:107], v[110:111], v[72:73], v[106:107]
    v_pk_mul_f32 v[40:41], v[40:41], v[42:43]
    v_pk_mul_f32 v[66:67], v[66:67], v[70:71]
    v_pk_mul_f32 v[64:65], v[64:65], v[68:69]
    v_pk_mul_f32 v[72:73], v[72:73], v[76:77]
    v_pk_mul_f32 v[42:43], v[40:41], v[64:65]
    v_pk_mul_f32 v[70:71], v[66:67], v[72:73]
    v_rcp_f32 v68, v42
    v_rcp_f32 v69, v43
    v_rcp_f32 v76, v70
    v_rcp_f32 v77, v71
    v_pk_mul_f32 v[96:97], v[96:97], v[64:65]
    v_pk_mul_f32 v[98:99], v[98:99], v[72:73]
    v_pk_fma_f32 v[96:97], v[104:105], v[40:41], v[96:97]
    v_pk_fma_f32 v[98:99], v[106:107], v[66:67], v[98:99]
    v_pk_fma_f32 v[36:37], v[96:97], v[68:69], v[36:37]
    v_pk_fma_f32 v[38:39], v[98:99], v[76:77], v[38:39]
K2_IT2:
    s_cmp_le_u32 s40, 4
    s_cbranch_scc1 K2_TL2
    s_waitcnt lgkmcnt(0)
    buffer_load_dwordx4 v[96:99], v[28:29], s[12:15], 0 idxen offen
    buffer_load_dwordx4 v[100:103], v[30:31], s[12:15], 0 idxen offen
    buffer_load_dwordx4 v[104:107], v[32:33], s[12:15], 0 idxen offen
    buffer_load_dwordx4 v[108:111], v[34:35], s[12:15], 0 idxen offen
K2_BD2:
    s_bitcmp1_b32 s46, 2
    s_cbranch_scc1 K2_FL2
K2_NF2:
    ds_read_u16 v28, v9 offset:35584
    ds_read_u16 v30, v9 offset:35588
    ds_read_u16 v32, v9 offset:35592
    ds_read_u16 v34, v9 offset:35596
    ds_read_u16 v9, v7 offset:96
    ds_read_u16 v44, v7 offset:56
    ds_read_u16_d16_hi v27, v10 offset:35586
    v_mfma_f32_16x16x4_4b_f16 v[64:79], v[16:17], v[12:13], 4.0 cbsz:2 abid:3
    s_waitcnt vmcnt(8) lgkmcnt(7)
    v_fma_mix_f32 v40, v112, v48, v20 op_sel_hi:[1,0,0]
    v_fma_mix_f32 v41, v113, v52, v21 op_sel_hi:[1,0,0]
    v_fma_mix_f32 v42, v116, v49, v20 op_sel_hi:[1,0,0]
    v_fma_mix_f32 v43, v117, v53, v21 op_sel_hi:[1,0,0]
    v_fma_mix_f32 v48, v120, v50, v20 op_sel_hi:[1,0,0]
    v_fma_mix_f32 v49, v121, v54, v21 op_sel_hi:[1,0,0]
    v_fma_mix_f32 v52, v124, v51, v20 op_sel_hi:[1,0,0]
    v_fma_mix_f32 v53, v125, v55, v21 op_sel_hi:[1,0,0]
    v_mfma_f32_16x16x4_4b_f16 v[64:79], v[18:19], v[14:15], v[64:79] cbsz:2 abid:3
    v_fma_mix_f32 v50, v114, v56, v22 op_sel_hi:[1,0,0]
    v_fma_mix_f32 v51, v115, v60, v23 op_sel_hi:[1,0,0]
    v_fma_mix_f32 v54, v118, v57, v22 op_sel_hi:[1,0,0]
    v_fma_mix_f32 v55, v119, v61, v23 op_sel_hi:[1,0,0]
    v_fma_mix_f32 v56, v122, v58, v22 op_sel_hi:[1,0,0]
    v_fma_mix_f32 v57, v123, v62, v23 op_sel_hi:[1,0,0]
    v_fma_mix_f32 v60, v126, v59, v22 op_sel_hi:[1,0,0]
    v_fma_mix_f32 v61, v127, v63, v23 op_sel_hi:[1,0,0]
    v_pk_mul_f32 v[112:113], v[112:113], v[42:43]
    v_pk_mul_f32 v[114:115], v[114:115], v[54:55]
    v_pk_mul_f32 v[120:121], v[120:121], v[52:53]
    v_pk_mul_f32 v[122:123], v[122:123], v[60:61]
    v_pk_fma_f32 v[112:113], v[116:117], v[40:41], v[112:113]
    v_pk_fma_f32 v[114:115], v[118:119], v[50:51], v[114:115]
    v_pk_fma_f32 v[120:121], v[124:125], v[48:49], v[120:121]
    v_pk_fma_f32 v[122:123], v[126:127], v[56:57], v[122:123]
    v_pk_mul_f32 v[40:41], v[40:41], v[42:43]
    v_pk_mul_f32 v[50:51], v[50:51], v[54:55]
    v_pk_mul_f32 v[48:49], v[48:49], v[52:53]
    v_pk_mul_f32 v[56:57], v[56:57], v[60:61]
    v_pk_mul_f32 v[42:43], v[40:41], v[48:49]
    v_pk_mul_f32 v[54:55], v[50:51], v[56:57]
    v_rcp_f32 v52, v42
    v_rcp_f32 v53, v43
    v_rcp_f32 v60, v54
    v_rcp_f32 v61, v55
    v_pk_mul_f32 v[112:113], v[112:113], v[48:49]
    v_pk_mul_f32 v[114:115], v[114:115], v[56:57]
    v_pk_fma_f32 v[112:113], v[120:121], v[40:41], v[112:113]
    v_pk_fma_f32 v[114:115], v[122:123], v[50:51], v[114:115]
    v_pk_fma_f32 v[36:37], v[112:113], v[52:53], v[36:37]
    v_pk_fma_f32 v[38:39], v[114:115], v[60:61], v[38:39]
K2_IT3:
    s_cmp_le_u32 s40, 5
    s_cbranch_scc1 K2_TL3
    s_waitcnt lgkmcnt(0)
    buffer_load_dwordx4 v[112:115], v[28:29], s[12:15], 0 idxen offen
    buffer_load_dwordx4 v[116:119], v[30:31], s[12:15], 0 idxen offen
    buffer_load_dwordx4 v[120:123], v[32:33], s[12:15], 0 idxen offen
    buffer_load_dwordx4 v[124:127], v[34:35], s[12:15], 0 idxen offen
K2_BD3:
    s_bitcmp1_b32 s46, 3
    s_cbranch_scc1 K2_FL3
K2_NF3:
    ds_read_u16 v28, v9 offset:35584
    ds_read_u16 v30, v9 offset:35588
    ds_read_u16 v32, v9 offset:35592
    ds_read_u16 v34, v9 offset:35596
    ds_read_u16 v9, v7 offset:112
    ds_read_u16 v44, v7 offset:72
    v_mul_f32 v25, v11, v27
    v_cmp_nle_f32_e64 vcc, abs(v27), s54
    s_or_b64 s[0:1], s[0:1], vcc
    v_mul_f32 v26, v25, v25
    v_cvt_pk_f16_f32 v16, v25, v26
    v_pk_mul_f16 v17, v16, v16 op_sel:[0,1] op_sel_hi:[1,1]
    v_fma_mix_f32 v25, v16, -1.0, v26 op_sel:[1,0,0] op_sel_hi:[1,0,0]
    v_pk_mul_f16 v18, v17, v16 op_sel:[0,1] op_sel_hi:[1,1]
    v_cvt_pk_f16_f32 v19, v25, v26
    v_mfma_f32_16x16x4_4b_f16 v[48:63], v[16:17], v[12:13], 4.0 cbsz:2 abid:0
    s_waitcnt vmcnt(8) lgkmcnt(6)
    v_fma_mix_f32 v40, v80, v64, v20 op_sel_hi:[1,0,0]
    v_fma_mix_f32 v41, v81, v68, v21 op_sel_hi:[1,0,0]
    v_fma_mix_f32 v42, v84, v65, v20 op_sel_hi:[1,0,0]
    v_fma_mix_f32 v43, v85, v69, v21 op_sel_hi:[1,0,0]
    v_fma_mix_f32 v64, v88, v66, v20 op_sel_hi:[1,0,0]
    v_fma_mix_f32 v65, v89, v70, v21 op_sel_hi:[1,0,0]
    v_fma_mix_f32 v68, v92, v67, v20 op_sel_hi:[1,0,0]
    v_fma_mix_f32 v69, v93, v71, v21 op_sel_hi:[1,0,0]
    v_mfma_f32_16x16x4_4b_f16 v[48:63], v[18:19], v[14:15], v[48:63] cbsz:2 abid:0
    v_fma_mix_f32 v66, v82, v72, v22 op_sel_hi:[1,0,0]
    v_fma_mix_f32 v67, v83, v76, v23 op_sel_hi:[1,0,0]
    v_fma_mix_f32 v70, v86, v73, v22 op_sel_hi:[1,0,0]
    v_fma_mix_f32 v71, v87, v77, v23 op_sel_hi:[1,0,0]
    v_fma_mix_f32 v72, v90, v74, v22 op_sel_hi:[1,0,0]
    v_fma_mix_f32 v73, v91, v78, v23 op_sel_hi:[1,0,0]
    v_fma_mix_f32 v76, v94, v75, v22 op_sel_hi:[1,0,0]
    v_fma_mix_f32 v77, v95, v79, v23 op_sel_hi:[1,0,0]
    v_pk_mul_f32 v[80:81], v[80:81], v[42:43]
    v_pk_mul_f32 v[82:83], v[82:83], v[70:71]
    v_pk_mul_f32 v[88:89], v[88:89], v[68:69]
    v_pk_mul_f32 v[90:91], v[90:91], v[76:77]
    v_pk_fma_f32 v[80:81], v[84:85], v[40:41], v[80:81]
    v_pk_fma_f32 v[82:83], v[86:87], v[66:67], v[82:83]
    v_pk_fma_f32 v[88:89], v[92:93], v[64:65], v[88:89]
    v_pk_fma_f32 v[90:91], v[94:95], v[72:73], v[90:91]
    v_pk_mul_f32 v[40:41], v[40:41], v[42:43]
    v_pk_mul_f32 v[66:67], v[66:67], v[70:71]
    v_pk_mul_f32 v[64:65], v[64:65], v[68:69]
    v_pk_mul_f32 v[72:73], v[72:73], v[76:77]
    v_pk_mul_f32 v[42:43], v[40:41], v[64:65]
    v_pk_mul_f32 v[70:71], v[66:67], v[72:73]
    v_rcp_f32 v68, v42
    v_rcp_f32 v69, v43
    v_rcp_f32 v76, v70
    v_rcp_f32 v77, v71
    v_pk_mul_f32 v[80:81], v[80:81], v[64:65]
    v_pk_mul_f32 v[82:83], v[82:83], v[72:73]
    v_pk_fma_f32 v[80:81], v[88:89], v[40:41], v[80:81]
    v_pk_fma_f32 v[82:83], v[90:91], v[66:67], v[82:83]
    v_pk_fma_f32 v[36:37], v[80:81], v[68:69], v[36:37]
    v_pk_fma_f32 v[38:39], v[82:83], v[76:77], v[38:39]
K2_IT4:
    s_cmp_le_u32 s40, 6
    s_cbranch_scc1 K2_TL4
    s_waitcnt lgkmcnt(0)
    buffer_load_dwordx4 v[80:83], v[28:29], s[12:15], 0 idxen offen
    buffer_load_dwordx4 v[84:87], v[30:31], s[12:15], 0 idxen offen
    buffer_load_dwordx4 v[88:91], v[32:33], s[12:15], 0 idxen offen
    buffer_load_dwordx4 v[92:95], v[34:35], s[12:15], 0 idxen offen
K2_BD4:
    s_bitcmp1_b32 s46, 4
    s_cbranch_scc1 K2_FL4
K2_NF4:
    ds_read_u16 v28, v9 offset:35584
    ds_read_u16 v30, v9 offset:35588
    ds_read_u16 v32, v9 offset:35592
    ds_read_u16 v34, v9 offset:35596
    ds_read_u16 v9, v7 offset:128
    ds_read_u16 v44, v7 offset:88
    v_mfma_f32_16x16x4_4b_f16 v[64:79], v[16:17], v[12:13], 4.0 cbsz:2 abid:1
    s_waitcnt vmcnt(8) lgkmcnt(6)
    v_fma_mix_f32 v40, v96, v48, v20 op_sel_hi:[1,0,0]
    v_fma_mix_f32 v41, v97, v52, v21 op_sel_hi:[1,0,0]
    v_fma_mix_f32 v42, v100, v49, v20 op_sel_hi:[1,0,0]
    v_fma_mix_f32 v43, v101, v53, v21 op_sel_hi:[1,0,0]
    v_fma_mix_f32 v48, v104, v50, v20 op_sel_hi:[1,0,0]
    v_fma_mix_f32 v49, v105, v54, v21 op_sel_hi:[1,0,0]
    v_fma_mix_f32 v52, v108, v51, v20 op_sel_hi:[1,0,0]
    v_fma_mix_f32 v53, v109, v55, v21 op_sel_hi:[1,0,0]
    v_mfma_f32_16x16x4_4b_f16 v[64:79], v[18:19], v[14:15], v[64:79] cbsz:2 abid:1
    v_fma_mix_f32 v50, v98, v56, v22 op_sel_hi:[1,0,0]
    v_fma_mix_f32 v51, v99, v60, v23 op_sel_hi:[1,0,0]
    v_fma_mix_f32 v54, v102, v57, v22 op_sel_hi:[1,0,0]
    v_fma_mix_f32 v55, v103, v61, v23 op_sel_hi:[1,0,0]
    v_fma_mix_f32 v56, v106, v58, v22 op_sel_hi:[1,0,0]
    v_fma_mix_f32 v57, v107, v62, v23 op_sel_hi:[1,0,0]
    v_fma_mix_f32 v60, v110, v59, v22 op_sel_hi:[1,0,0]
    v_fma_mix_f32 v61, v111, v63, v23 op_sel_hi:[1,0,0]
    v_pk_mul_f32 v[96:97], v[96:97], v[42:43]
    v_pk_mul_f32 v[98:99], v[98:99], v[54:55]
    v_pk_mul_f32 v[104:105], v[104:105], v[52:53]
    v_pk_mul_f32 v[106:107], v[106:107], v[60:61]
    v_pk_fma_f32 v[96:97], v[100:101], v[40:41], v[96:97]
    v_pk_fma_f32 v[98:99], v[102:103], v[50:51], v[98:99]
    v_pk_fma_f32 v[104:105], v[108:109], v[48:49], v[104:105]
    v_pk_fma_f32 v[106:107], v[110:111], v[56:57], v[106:107]
    v_pk_mul_f32 v[40:41], v[40:41], v[42:43]
    v_pk_mul_f32 v[50:51], v[50:51], v[54:55]
    v_pk_mul_f32 v[48:49], v[48:49], v[52:53]
    v_pk_mul_f32 v[56:57], v[56:57], v[60:61]
    v_pk_mul_f32 v[42:43], v[40:41], v[48:49]
    v_pk_mul_f32 v[54:55], v[50:51], v[56:57]
    v_rcp_f32 v52, v42
    v_rcp_f32 v53, v43
    v_rcp_f32 v60, v54
    v_rcp_f32 v61, v55
    v_pk_mul_f32 v[96:97], v[96:97], v[48:49]
    v_pk_mul_f32 v[98:99], v[98:99], v[56:57]
    v_pk_fma_f32 v[96:97], v[104:105], v[40:41], v[96:97]
    v_pk_fma_f32 v[98:99], v[106:107], v[50:51], v[98:99]
    v_pk_fma_f32 v[36:37], v[96:97], v[52:53], v[36:37]
    v_pk_fma_f32 v[38:39], v[98:99], v[60:61], v[38:39]
K2_IT5:
    s_cmp_le_u32 s40, 7
    s_cbranch_scc1 K2_TL5
    s_waitcnt lgkmcnt(0)
    buffer_load_dwordx4 v[96:99], v[28:29], s[12:15], 0 idxen offen
    buffer_load_dwordx4 v[100:103], v[30:31], s[12:15], 0 idxen offen
    buffer_load_dwordx4 v[104:107], v[32:33], s[12:15], 0 idxen offen
    buffer_load_dwordx4 v[108:111], v[34:35], s[12:15], 0 idxen offen
K2_BD5:
    s_bitcmp1_b32 s46, 5
    s_cbranch_scc1 K2_FL5
K2_NF5:
    ds_read_u16 v28, v9 offset:35584
    ds_read_u16 v30, v9 offset:35588
    ds_read_u16 v32, v9 offset:35592
    ds_read_u16 v34, v9 offset:35596
    ds_read_u16 v9, v7 offset:144
    ds_read_u16 v44, v7 offset:104
    ds_read_u16 v10, v8 offset:128
    v_mfma_f32_16x16x4_4b_f16 v[48:63], v[16:17], v[12:13], 4.0 cbsz:2 abid:2
    s_waitcnt vmcnt(8) lgkmcnt(7)
    v_fma_mix_f32 v40, v112, v64, v20 op_sel_hi:[1,0,0]
    v_fma_mix_f32 v41, v113, v68, v21 op_sel_hi:[1,0,0]
    v_fma_mix_f32 v42, v116, v65, v20 op_sel_hi:[1,0,0]
    v_fma_mix_f32 v43, v117, v69, v21 op_sel_hi:[1,0,0]
    v_fma_mix_f32 v64, v120, v66, v20 op_sel_hi:[1,0,0]
    v_fma_mix_f32 v65, v121, v70, v21 op_sel_hi:[1,0,0]
    v_fma_mix_f32 v68, v124, v67, v20 op_sel_hi:[1,0,0]
    v_fma_mix_f32 v69, v125, v71, v21 op_sel_hi:[1,0,0]
    v_mfma_f32_16x16x4_4b_f16 v[48:63], v[18:19], v[14:15], v[48:63] cbsz:2 abid:2
    v_fma_mix_f32 v66, v114, v72, v22 op_sel_hi:[1,0,0]
    v_fma_mix_f32 v67, v115, v76, v23 op_sel_hi:[1,0,0]
    v_fma_mix_f32 v70, v118, v73, v22 op_sel_hi:[1,0,0]
    v_fma_mix_f32 v71, v119, v77, v23 op_sel_hi:[1,0,0]
    v_fma_mix_f32 v72, v122, v74, v22 op_sel_hi:[1,0,0]
    v_fma_mix_f32 v73, v123, v78, v23 op_sel_hi:[1,0,0]
    v_fma_mix_f32 v76, v126, v75, v22 op_sel_hi:[1,0,0]
    v_fma_mix_f32 v77, v127, v79, v23 op_sel_hi:[1,0,0]
    v_pk_mul_f32 v[112:113], v[112:113], v[42:43]
    v_pk_mul_f32 v[114:115], v[114:115], v[70:71]
    v_pk_mul_f32 v[120:121], v[120:121], v[68:69]
    v_pk_mul_f32 v[122:123], v[122:123], v[76:77]
    v_pk_fma_f32 v[112:113], v[116:117], v[40:41], v[112:113]
    v_pk_fma_f32 v[114:115], v[118:119], v[66:67], v[114:115]
    v_pk_fma_f32 v[120:121], v[124:125], v[64:65], v[120:121]
    v_pk_fma_f32 v[122:123], v[126:127], v[72:73], v[122:123]
    v_pk_mul_f32 v[40:41], v[40:41], v[42:43]
    v_pk_mul_f32 v[66:67], v[66:67], v[70:71]
    v_pk_mul_f32 v[64:65], v[64:65], v[68:69]
    v_pk_mul_f32 v[72:73], v[72:73], v[76:77]
    v_pk_mul_f32 v[42:43], v[40:41], v[64:65]
    v_pk_mul_f32 v[70:71], v[66:67], v[72:73]
    v_rcp_f32 v68, v42
    v_rcp_f32 v69, v43
    v_rcp_f32 v76, v70
    v_rcp_f32 v77, v71
    v_pk_mul_f32 v[112:113], v[112:113], v[64:65]
    v_pk_mul_f32 v[114:115], v[114:115], v[72:73]
    v_pk_fma_f32 v[112:113], v[120:121], v[40:41], v[112:113]
    v_pk_fma_f32 v[114:115], v[122:123], v[66:67], v[114:115]
    v_pk_fma_f32 v[36:37], v[112:113], v[68:69], v[36:37]
    v_pk_fma_f32 v[38:39], v[114:115], v[76:77], v[38:39]
K2_IT6:
    s_cmp_lt_u32 s3, 12
    s_cbranch_scc1 K2_PRC
    s_setprio 0
K2_PRC:
    s_cmp_le_u32 s40, 8
    s_cbranch_scc1 K2_TL6
    s_waitcnt lgkmcnt(0)
    buffer_load_dwordx4 v[112:115], v[28:29], s[12:15], 0 idxen offen
    buffer_load_dwordx4 v[116:119], v[30:31], s[12:15], 0 idxen offen
    buffer_load_dwordx4 v[120:123], v[32:33], s[12:15], 0 idxen offen
    buffer_load_dwordx4 v[124:127], v[34:35], s[12:15], 0 idxen offen
K2_BD6:
    s_bitcmp1_b32 s46, 6
    s_cbranch_scc1 K2_FL6
K2_NF6:
    ds_read_u16 v28, v9 offset:35584
    ds_read_u16 v30, v9 offset:35588
    ds_read_u16 v32, v9 offset:35592
    ds_read_u16 v34, v9 offset:35596
    ds_read_u16 v9, v7 offset:160
    ds_read_u16 v44, v7 offset:120
    ds_read_u16_d16_hi v27, v10 offset:35586
    v_mfma_f32_16x16x4_4b_f16 v[64:79], v[16:17], v[12:13], 4.0 cbsz:2 abid:3
    s_waitcnt vmcnt(8) lgkmcnt(7)
    v_fma_mix_f32 v40, v80, v48, v20 op_sel_hi:[1,0,0]
    v_fma_mix_f32 v41, v81, v52, v21 op_sel_hi:[1,0,0]
    v_fma_mix_f32 v42, v84, v49, v20 op_sel_hi:[1,0,0]
    v_fma_mix_f32 v43, v85, v53, v21 op_sel_hi:[1,0,0]
    v_fma_mix_f32 v48, v88, v50, v20 op_sel_hi:[1,0,0]
    v_fma_mix_f32 v49, v89, v54, v21 op_sel_hi:[1,0,0]
    v_fma_mix_f32 v52, v92, v51, v20 op_sel_hi:[1,0,0]
    v_fma_mix_f32 v53, v93, v55, v21 op_sel_hi:[1,0,0]
    v_mfma_f32_16x16x4_4b_f16 v[64:79], v[18:19], v[14:15], v[64:79] cbsz:2 abid:3
    v_fma_mix_f32 v50, v82, v56, v22 op_sel_hi:[1,0,0]
    v_fma_mix_f32 v51, v83, v60, v23 op_sel_hi:[1,0,0]
    v_fma_mix_f32 v54, v86, v57, v22 op_sel_hi:[1,0,0]
    v_fma_mix_f32 v55, v87, v61, v23 op_sel_hi:[1,0,0]
    v_fma_mix_f32 v56, v90, v58, v22 op_sel_hi:[1,0,0]
    v_fma_mix_f32 v57, v91, v62, v23 op_sel_hi:[1,0,0]
    v_fma_mix_f32 v60, v94, v59, v22 op_sel_hi:[1,0,0]
    v_fma_mix_f32 v61, v95, v63, v23 op_sel_hi:[1,0,0]
    v_pk_mul_f32 v[80:81], v[80:81], v[42:43]
    v_pk_mul_f32 v[82:83], v[82:83], v[54:55]
    v_pk_mul_f32 v[88:89], v[88:89], v[52:53]
    v_pk_mul_f32 v[90:91], v[90:91], v[60:61]
    v_pk_fma_f32 v[80:81], v[84:85], v[40:41], v[80:81]
    v_pk_fma_f32 v[82:83], v[86:87], v[50:51], v[82:83]
    v_pk_fma_f32 v[88:89], v[92:93], v[48:49], v[88:89]
    v_pk_fma_f32 v[90:91], v[94:95], v[56:57], v[90:91]
    v_pk_mul_f32 v[40:41], v[40:41], v[42:43]
    v_pk_mul_f32 v[50:51], v[50:51], v[54:55]
    v_pk_mul_f32 v[48:49], v[48:49], v[52:53]
    v_pk_mul_f32 v[56:57], v[56:57], v[60:61]
    v_pk_mul_f32 v[42:43], v[40:41], v[48:49]
    v_pk_mul_f32 v[54:55], v[50:51], v[56:57]
    v_rcp_f32 v52, v42
    v_rcp_f32 v53, v43
    v_rcp_f32 v60, v54
    v_rcp_f32 v61, v55
    v_pk_mul_f32 v[80:81], v[80:81], v[48:49]
    v_pk_mul_f32 v[82:83], v[82:83], v[56:57]
    v_pk_fma_f32 v[80:81], v[88:89], v[40:41], v[80:81]
    v_pk_fma_f32 v[82:83], v[90:91], v[50:51], v[82:83]
    v_pk_fma_f32 v[36:37], v[80:81], v[52:53], v[36:37]
    v_pk_fma_f32 v[38:39], v[82:83], v[60:61], v[38:39]
K2_IT7:
    s_cmp_le_u32 s40, 9
    s_cbranch_scc1 K2_TL7
    s_waitcnt lgkmcnt(0)
    buffer_load_dwordx4 v[80:83], v[28:29], s[12:15], 0 idxen offen
    buffer_load_dwordx4 v[84:87], v[30:31], s[12:15], 0 idxen offen
    buffer_load_dwordx4 v[88:91], v[32:33], s[12:15], 0 idxen offen
    buffer_load_dwordx4 v[92:95], v[34:35], s[12:15], 0 idxen offen
K2_BD7:
    s_bitcmp1_b32 s46, 7
    s_cbranch_scc1 K2_FL7
K2_NF7:
    ds_read_u16 v28, v9 offset:35584
    ds_read_u16 v30, v9 offset:35588
    ds_read_u16 v32, v9 offset:35592
    ds_read_u16 v34, v9 offset:35596
    ds_read_u16 v9, v7 offset:176
    ds_read_u16 v44, v7 offset:136
    v_mul_f32 v25, v11, v27
    v_cmp_nle_f32_e64 vcc, abs(v27), s54
    s_or_b64 s[0:1], s[0:1], vcc
    v_mul_f32 v26, v25, v25
    v_cvt_pk_f16_f32 v16, v25, v26
    v_pk_mul_f16 v17, v16, v16 op_sel:[0,1] op_sel_hi:[1,1]
    v_fma_mix_f32 v25, v16, -1.0, v26 op_sel:[1,0,0] op_sel_hi:[1,0,0]
    v_pk_mul_f16 v18, v17, v16 op_sel:[0,1] op_sel_hi:[1,1]
    v_cvt_pk_f16_f32 v19, v25, v26
    v_mfma_f32_16x16x4_4b_f16 v[48:63], v[16:17], v[12:13], 4.0 cbsz:2 abid:0
    s_waitcnt vmcnt(8) lgkmcnt(6)
    v_fma_mix_f32 v40, v96, v64, v20 op_sel_hi:[1,0,0]
    v_fma_mix_f32 v41, v97, v68, v21 op_sel_hi:[1,0,0]
    v_fma_mix_f32 v42, v100, v65, v20 op_sel_hi:[1,0,0]
    v_fma_mix_f32 v43, v101, v69, v21 op_sel_hi:[1,0,0]
    v_fma_mix_f32 v64, v104, v66, v20 op_sel_hi:[1,0,0]
    v_fma_mix_f32 v65, v105, v70, v21 op_sel_hi:[1,0,0]
    v_fma_mix_f32 v68, v108, v67, v20 op_sel_hi:[1,0,0]
    v_fma_mix_f32 v69, v109, v71, v21 op_sel_hi:[1,0,0]
    v_mfma_f32_16x16x4_4b_f16 v[48:63], v[18:19], v[14:15], v[48:63] cbsz:2 abid:0
    v_fma_mix_f32 v66, v98, v72, v22 op_sel_hi:[1,0,0]
    v_fma_mix_f32 v67, v99, v76, v23 op_sel_hi:[1,0,0]
    v_fma_mix_f32 v70, v102, v73, v22 op_sel_hi:[1,0,0]
    v_fma_mix_f32 v71, v103, v77, v23 op_sel_hi:[1,0,0]
    v_fma_mix_f32 v72, v106, v74, v22 op_sel_hi:[1,0,0]
    v_fma_mix_f32 v73, v107, v78, v23 op_sel_hi:[1,0,0]
    v_fma_mix_f32 v76, v110, v75, v22 op_sel_hi:[1,0,0]
    v_fma_mix_f32 v77, v111, v79, v23 op_sel_hi:[1,0,0]
    v_pk_mul_f32 v[96:97], v[96:97], v[42:43]
    v_pk_mul_f32 v[98:99], v[98:99], v[70:71]
    v_pk_mul_f32 v[104:105], v[104:105], v[68:69]
    v_pk_mul_f32 v[106:107], v[106:107], v[76:77]
    v_pk_fma_f32 v[96:97], v[100:101], v[40:41], v[96:97]
    v_pk_fma_f32 v[98:99], v[102:103], v[66:67], v[98:99]
    v_pk_fma_f32 v[104:105], v[108:109], v[64:65], v[104:105]
    v_pk_fma_f32 v[106:107], v[110:111], v[72:73], v[106:107]
    v_pk_mul_f32 v[40:41], v[40:41], v[42:43]
    v_pk_mul_f32 v[66:67], v[66:67], v[70:71]
    v_pk_mul_f32 v[64:65], v[64:65], v[68:69]
    v_pk_mul_f32 v[72:73], v[72:73], v[76:77]
    v_pk_mul_f32 v[42:43], v[40:41], v[64:65]
    v_pk_mul_f32 v[70:71], v[66:67], v[72:73]
    v_rcp_f32 v68, v42
    v_rcp_f32 v69, v43
    v_rcp_f32 v76, v70
    v_rcp_f32 v77, v71
    v_pk_mul_f32 v[96:97], v[96:97], v[64:65]
    v_pk_mul_f32 v[98:99], v[98:99], v[72:73]
    v_pk_fma_f32 v[96:97], v[104:105], v[40:41], v[96:97]
    v_pk_fma_f32 v[98:99], v[106:107], v[66:67], v[98:99]
    v_pk_fma_f32 v[36:37], v[96:97], v[68:69], v[36:37]
    v_pk_fma_f32 v[38:39], v[98:99], v[76:77], v[38:39]
K2_IT8:
    s_cmp_le_u32 s40, 10
    s_cbranch_scc1 K2_TL8
    s_waitcnt lgkmcnt(0)
    buffer_load_dwordx4 v[96:99], v[28:29], s[12:15], 0 idxen offen
    buffer_load_dwordx4 v[100:103], v[30:31], s[12:15], 0 idxen offen
    buffer_load_dwordx4 v[104:107], v[32:33], s[12:15], 0 idxen offen
    buffer_load_dwordx4 v[108:111], v[34:35], s[12:15], 0 idxen offen
K2_BD8:
    s_bitcmp1_b32 s46, 8
    s_cbranch_scc1 K2_FL8
K2_NF8:
    ds_read_u16 v28, v9 offset:35584
    ds_read_u16 v30, v9 offset:35588
    ds_read_u16 v32, v9 offset:35592
    ds_read_u16 v34, v9 offset:35596
    ds_read_u16 v9, v7 offset:192
    ds_read_u16 v44, v7 offset:152
    v_mfma_f32_16x16x4_4b_f16 v[64:79], v[16:17], v[12:13], 4.0 cbsz:2 abid:1
    s_waitcnt vmcnt(8) lgkmcnt(6)
    v_fma_mix_f32 v40, v112, v48, v20 op_sel_hi:[1,0,0]
    v_fma_mix_f32 v41, v113, v52, v21 op_sel_hi:[1,0,0]
    v_fma_mix_f32 v42, v116, v49, v20 op_sel_hi:[1,0,0]
    v_fma_mix_f32 v43, v117, v53, v21 op_sel_hi:[1,0,0]
    v_fma_mix_f32 v48, v120, v50, v20 op_sel_hi:[1,0,0]
    v_fma_mix_f32 v49, v121, v54, v21 op_sel_hi:[1,0,0]
    v_fma_mix_f32 v52, v124, v51, v20 op_sel_hi:[1,0,0]
    v_fma_mix_f32 v53, v125, v55, v21 op_sel_hi:[1,0,0]
    v_mfma_f32_16x16x4_4b_f16 v[64:79], v[18:19], v[14:15], v[64:79] cbsz:2 abid:1
    v_fma_mix_f32 v50, v114, v56, v22 op_sel_hi:[1,0,0]
    v_fma_mix_f32 v51, v115, v60, v23 op_sel_hi:[1,0,0]
    v_fma_mix_f32 v54, v118, v57, v22 op_sel_hi:[1,0,0]
    v_fma_mix_f32 v55, v119, v61, v23 op_sel_hi:[1,0,0]
    v_fma_mix_f32 v56, v122, v58, v22 op_sel_hi:[1,0,0]
    v_fma_mix_f32 v57, v123, v62, v23 op_sel_hi:[1,0,0]
    v_fma_mix_f32 v60, v126, v59, v22 op_sel_hi:[1,0,0]
    v_fma_mix_f32 v61, v127, v63, v23 op_sel_hi:[1,0,0]
    v_pk_mul_f32 v[112:113], v[112:113], v[42:43]
    v_pk_mul_f32 v[114:115], v[114:115], v[54:55]
    v_pk_mul_f32 v[120:121], v[120:121], v[52:53]
    v_pk_mul_f32 v[122:123], v[122:123], v[60:61]
    v_pk_fma_f32 v[112:113], v[116:117], v[40:41], v[112:113]
    v_pk_fma_f32 v[114:115], v[118:119], v[50:51], v[114:115]
    v_pk_fma_f32 v[120:121], v[124:125], v[48:49], v[120:121]
    v_pk_fma_f32 v[122:123], v[126:127], v[56:57], v[122:123]
    v_pk_mul_f32 v[40:41], v[40:41], v[42:43]
    v_pk_mul_f32 v[50:51], v[50:51], v[54:55]
    v_pk_mul_f32 v[48:49], v[48:49], v[52:53]
    v_pk_mul_f32 v[56:57], v[56:57], v[60:61]
    v_pk_mul_f32 v[42:43], v[40:41], v[48:49]
    v_pk_mul_f32 v[54:55], v[50:51], v[56:57]
    v_rcp_f32 v52, v42
    v_rcp_f32 v53, v43
    v_rcp_f32 v60, v54
    v_rcp_f32 v61, v55
    v_pk_mul_f32 v[112:113], v[112:113], v[48:49]
    v_pk_mul_f32 v[114:115], v[114:115], v[56:57]
    v_pk_fma_f32 v[112:113], v[120:121], v[40:41], v[112:113]
    v_pk_fma_f32 v[114:115], v[122:123], v[50:51], v[114:115]
    v_pk_fma_f32 v[36:37], v[112:113], v[52:53], v[36:37]
    v_pk_fma_f32 v[38:39], v[114:115], v[60:61], v[38:39]
K2_IT9:
    s_cmp_le_u32 s40, 11
    s_cbranch_scc1 K2_TL9
    s_waitcnt lgkmcnt(0)
    buffer_load_dwordx4 v[112:115], v[28:29], s[12:15], 0 idxen offen
    buffer_load_dwordx4 v[116:119], v[30:31], s[12:15], 0 idxen offen
    buffer_load_dwordx4 v[120:123], v[32:33], s[12:15], 0 idxen offen
    buffer_load_dwordx4 v[124:127], v[34:35], s[12:15], 0 idxen offen
K2_BD9:
    s_bitcmp1_b32 s46, 9
    s_cbranch_scc1 K2_FL9
K2_NF9:
    ds_read_u16 v28, v9 offset:35584
    ds_read_u16 v30, v9 offset:35588
    ds_read_u16 v32, v9 offset:35592
    ds_read_u16 v34, v9 offset:35596
    ds_read_u16 v9, v7 offset:208
    ds_read_u16 v44, v7 offset:168
    ds_read_u16 v10, v8 offset:192
    v_mfma_f32_16x16x4_4b_f16 v[48:63], v[16:17], v[12:13], 4.0 cbsz:2 abid:2
    s_waitcnt vmcnt(8) lgkmcnt(7)
    v_fma_mix_f32 v40, v80, v64, v20 op_sel_hi:[1,0,0]
    v_fma_mix_f32 v41, v81, v68, v21 op_sel_hi:[1,0,0]
    v_fma_mix_f32 v42, v84, v65, v20 op_sel_hi:[1,0,0]
    v_fma_mix_f32 v43, v85, v69, v21 op_sel_hi:[1,0,0]
    v_fma_mix_f32 v64, v88, v66, v20 op_sel_hi:[1,0,0]
    v_fma_mix_f32 v65, v89, v70, v21 op_sel_hi:[1,0,0]
    v_fma_mix_f32 v68, v92, v67, v20 op_sel_hi:[1,0,0]
    v_fma_mix_f32 v69, v93, v71, v21 op_sel_hi:[1,0,0]
    v_mfma_f32_16x16x4_4b_f16 v[48:63], v[18:19], v[14:15], v[48:63] cbsz:2 abid:2
    v_fma_mix_f32 v66, v82, v72, v22 op_sel_hi:[1,0,0]
    v_fma_mix_f32 v67, v83, v76, v23 op_sel_hi:[1,0,0]
    v_fma_mix_f32 v70, v86, v73, v22 op_sel_hi:[1,0,0]
    v_fma_mix_f32 v71, v87, v77, v23 op_sel_hi:[1,0,0]
    v_fma_mix_f32 v72, v90, v74, v22 op_sel_hi:[1,0,0]
    v_fma_mix_f32 v73, v91, v78, v23 op_sel_hi:[1,0,0]
    v_fma_mix_f32 v76, v94, v75, v22 op_sel_hi:[1,0,0]
    v_fma_mix_f32 v77, v95, v79, v23 op_sel_hi:[1,0,0]
    v_pk_mul_f32 v[80:81], v[80:81], v[42:43]
    v_pk_mul_f32 v[82:83], v[82:83], v[70:71]
    v_pk_mul_f32 v[88:89], v[88:89], v[68:69]
    v_pk_mul_f32 v[90:91], v[90:91], v[76:77]
    v_pk_fma_f32 v[80:81], v[84:85], v[40:41], v[80:81]
    v_pk_fma_f32 v[82:83], v[86:87], v[66:67], v[82:83]
    v_pk_fma_f32 v[88:89], v[92:93], v[64:65], v[88:89]
    v_pk_fma_f32 v[90:91], v[94:95], v[72:73], v[90:91]
    v_pk_mul_f32 v[40:41], v[40:41], v[42:43]
    v_pk_mul_f32 v[66:67], v[66:67], v[70:71]
    v_pk_mul_f32 v[64:65], v[64:65], v[68:69]
    v_pk_mul_f32 v[72:73], v[72:73], v[76:77]
    v_pk_mul_f32 v[42:43], v[40:41], v[64:65]
    v_pk_mul_f32 v[70:71], v[66:67], v[72:73]
    v_rcp_f32 v68, v42
    v_rcp_f32 v69, v43
    v_rcp_f32 v76, v70
    v_rcp_f32 v77, v71
    v_pk_mul_f32 v[80:81], v[80:81], v[64:65]
    v_pk_mul_f32 v[82:83], v[82:83], v[72:73]
    v_pk_fma_f32 v[80:81], v[88:89], v[40:41], v[80:81]
    v_pk_fma_f32 v[82:83], v[90:91], v[66:67], v[82:83]
    v_pk_fma_f32 v[36:37], v[80:81], v[68:69], v[36:37]
    v_pk_fma_f32 v[38:39], v[82:83], v[76:77], v[38:39]
K2_IT10:
    s_cmp_le_u32 s40, 12
    s_cbranch_scc1 K2_TL10
    s_waitcnt lgkmcnt(0)
    buffer_load_dwordx4 v[80:83], v[28:29], s[12:15], 0 idxen offen
    buffer_load_dwordx4 v[84:87], v[30:31], s[12:15], 0 idxen offen
    buffer_load_dwordx4 v[88:91], v[32:33], s[12:15], 0 idxen offen
    buffer_load_dwordx4 v[92:95], v[34:35], s[12:15], 0 idxen offen
K2_BD10:
    s_bitcmp1_b32 s46, 10
    s_cbranch_scc1 K2_FL10
K2_NF10:
    ds_read_u16 v28, v9 offset:35584
    ds_read_u16 v30, v9 offset:35588
    ds_read_u16 v32, v9 offset:35592
    ds_read_u16 v34, v9 offset:35596
    ds_read_u16 v9, v7 offset:224
    ds_read_u16 v44, v7 offset:184
    ds_read_u16_d16_hi v27, v10 offset:35586
    v_mfma_f32_16x16x4_4b_f16 v[64:79], v[16:17], v[12:13], 4.0 cbsz:2 abid:3
    s_waitcnt vmcnt(8) lgkmcnt(7)
    v_fma_mix_f32 v40, v96, v48, v20 op_sel_hi:[1,0,0]
    v_fma_mix_f32 v41, v97, v52, v21 op_sel_hi:[1,0,0]
    v_fma_mix_f32 v42, v100, v49, v20 op_sel_hi:[1,0,0]
    v_fma_mix_f32 v43, v101, v53, v21 op_sel_hi:[1,0,0]
    v_fma_mix_f32 v48, v104, v50, v20 op_sel_hi:[1,0,0]
    v_fma_mix_f32 v49, v105, v54, v21 op_sel_hi:[1,0,0]
    v_fma_mix_f32 v52, v108, v51, v20 op_sel_hi:[1,0,0]
    v_fma_mix_f32 v53, v109, v55, v21 op_sel_hi:[1,0,0]
    v_mfma_f32_16x16x4_4b_f16 v[64:79], v[18:19], v[14:15], v[64:79] cbsz:2 abid:3
    v_fma_mix_f32 v50, v98, v56, v22 op_sel_hi:[1,0,0]
    v_fma_mix_f32 v51, v99, v60, v23 op_sel_hi:[1,0,0]
    v_fma_mix_f32 v54, v102, v57, v22 op_sel_hi:[1,0,0]
    v_fma_mix_f32 v55, v103, v61, v23 op_sel_hi:[1,0,0]
    v_fma_mix_f32 v56, v106, v58, v22 op_sel_hi:[1,0,0]
    v_fma_mix_f32 v57, v107, v62, v23 op_sel_hi:[1,0,0]
    v_fma_mix_f32 v60, v110, v59, v22 op_sel_hi:[1,0,0]
    v_fma_mix_f32 v61, v111, v63, v23 op_sel_hi:[1,0,0]
    v_pk_mul_f32 v[96:97], v[96:97], v[42:43]
    v_pk_mul_f32 v[98:99], v[98:99], v[54:55]
    v_pk_mul_f32 v[104:105], v[104:105], v[52:53]
    v_pk_mul_f32 v[106:107], v[106:107], v[60:61]
    v_pk_fma_f32 v[96:97], v[100:101], v[40:41], v[96:97]
    v_pk_fma_f32 v[98:99], v[102:103], v[50:51], v[98:99]
    v_pk_fma_f32 v[104:105], v[108:109], v[48:49], v[104:105]
    v_pk_fma_f32 v[106:107], v[110:111], v[56:57], v[106:107]
    v_pk_mul_f32 v[40:41], v[40:41], v[42:43]
    v_pk_mul_f32 v[50:51], v[50:51], v[54:55]
    v_pk_mul_f32 v[48:49], v[48:49], v[52:53]
    v_pk_mul_f32 v[56:57], v[56:57], v[60:61]
    v_pk_mul_f32 v[42:43], v[40:41], v[48:49]
    v_pk_mul_f32 v[54:55], v[50:51], v[56:57]
    v_rcp_f32 v52, v42
    v_rcp_f32 v53, v43
    v_rcp_f32 v60, v54
    v_rcp_f32 v61, v55
    v_pk_mul_f32 v[96:97], v[96:97], v[48:49]
    v_pk_mul_f32 v[98:99], v[98:99], v[56:57]
    v_pk_fma_f32 v[96:97], v[104:105], v[40:41], v[96:97]
    v_pk_fma_f32 v[98:99], v[106:107], v[50:51], v[98:99]
    v_pk_fma_f32 v[36:37], v[96:97], v[52:53], v[36:37]
    v_pk_fma_f32 v[38:39], v[98:99], v[60:61], v[38:39]
K2_IT11:
    s_cmp_le_u32 s40, 13
    s_cbranch_scc1 K2_TL11
    s_waitcnt lgkmcnt(0)
    buffer_load_dwordx4 v[96:99], v[28:29], s[12:15], 0 idxen offen
    buffer_load_dwordx4 v[100:103], v[30:31], s[12:15], 0 idxen offen
    buffer_load_dwordx4 v[104:107], v[32:33], s[12:15], 0 idxen offen
    buffer_load_dwordx4 v[108:111], v[34:35], s[12:15], 0 idxen offen
K2_BD11:
    s_bitcmp1_b32 s46, 11
    s_cbranch_scc1 K2_FL11
K2_NF11:
    ds_read_u16 v28, v9 offset:35584
    ds_read_u16 v30, v9 offset:35588
    ds_read_u16 v32, v9 offset:35592
    ds_read_u16 v34, v9 offset:35596
    ds_read_u16 v9, v7 offset:240
    ds_read_u16 v44, v7 offset:200
    v_mul_f32 v25, v11, v27
    v_cmp_nle_f32_e64 vcc, abs(v27), s54
    s_or_b64 s[0:1], s[0:1], vcc
    v_mul_f32 v26, v25, v25
    v_cvt_pk_f16_f32 v16, v25, v26
    v_pk_mul_f16 v17, v16, v16 op_sel:[0,1] op_sel_hi:[1,1]
    v_fma_mix_f32 v25, v16, -1.0, v26 op_sel:[1,0,0] op_sel_hi:[1,0,0]
    v_pk_mul_f16 v18, v17, v16 op_sel:[0,1] op_sel_hi:[1,1]
    v_cvt_pk_f16_f32 v19, v25, v26
    v_mfma_f32_16x16x4_4b_f16 v[48:63], v[16:17], v[12:13], 4.0 cbsz:2 abid:0
    s_waitcnt vmcnt(8) lgkmcnt(6)
    v_fma_mix_f32 v40, v112, v64, v20 op_sel_hi:[1,0,0]
    v_fma_mix_f32 v41, v113, v68, v21 op_sel_hi:[1,0,0]
    v_fma_mix_f32 v42, v116, v65, v20 op_sel_hi:[1,0,0]
    v_fma_mix_f32 v43, v117, v69, v21 op_sel_hi:[1,0,0]
    v_fma_mix_f32 v64, v120, v66, v20 op_sel_hi:[1,0,0]
    v_fma_mix_f32 v65, v121, v70, v21 op_sel_hi:[1,0,0]
    v_fma_mix_f32 v68, v124, v67, v20 op_sel_hi:[1,0,0]
    v_fma_mix_f32 v69, v125, v71, v21 op_sel_hi:[1,0,0]
    v_mfma_f32_16x16x4_4b_f16 v[48:63], v[18:19], v[14:15], v[48:63] cbsz:2 abid:0
    v_fma_mix_f32 v66, v114, v72, v22 op_sel_hi:[1,0,0]
    v_fma_mix_f32 v67, v115, v76, v23 op_sel_hi:[1,0,0]
    v_fma_mix_f32 v70, v118, v73, v22 op_sel_hi:[1,0,0]
    v_fma_mix_f32 v71, v119, v77, v23 op_sel_hi:[1,0,0]
    v_fma_mix_f32 v72, v122, v74, v22 op_sel_hi:[1,0,0]
    v_fma_mix_f32 v73, v123, v78, v23 op_sel_hi:[1,0,0]
    v_fma_mix_f32 v76, v126, v75, v22 op_sel_hi:[1,0,0]
    v_fma_mix_f32 v77, v127, v79, v23 op_sel_hi:[1,0,0]
    v_pk_mul_f32 v[112:113], v[112:113], v[42:43]
    v_pk_mul_f32 v[114:115], v[114:115], v[70:71]
    v_pk_mul_f32 v[120:121], v[120:121], v[68:69]
    v_pk_mul_f32 v[122:123], v[122:123], v[76:77]
    v_pk_fma_f32 v[112:113], v[116:117], v[40:41], v[112:113]
    v_pk_fma_f32 v[114:115], v[118:119], v[66:67], v[114:115]
    v_pk_fma_f32 v[120:121], v[124:125], v[64:65], v[120:121]
    v_pk_fma_f32 v[122:123], v[126:127], v[72:73], v[122:123]
    v_pk_mul_f32 v[40:41], v[40:41], v[42:43]
    v_pk_mul_f32 v[66:67], v[66:67], v[70:71]
    v_pk_mul_f32 v[64:65], v[64:65], v[68:69]
    v_pk_mul_f32 v[72:73], v[72:73], v[76:77]
    v_pk_mul_f32 v[42:43], v[40:41], v[64:65]
    v_pk_mul_f32 v[70:71], v[66:67], v[72:73]
    v_rcp_f32 v68, v42
    v_rcp_f32 v69, v43
    v_rcp_f32 v76, v70
    v_rcp_f32 v77, v71
    v_pk_mul_f32 v[112:113], v[112:113], v[64:65]
    v_pk_mul_f32 v[114:115], v[114:115], v[72:73]
    v_pk_fma_f32 v[112:113], v[120:121], v[40:41], v[112:113]
    v_pk_fma_f32 v[114:115], v[122:123], v[66:67], v[114:115]
    v_pk_fma_f32 v[36:37], v[112:113], v[68:69], v[36:37]
    v_pk_fma_f32 v[38:39], v[114:115], v[76:77], v[38:39]
K2_IT12:
    s_cmp_le_u32 s40, 14
    s_cbranch_scc1 K2_TL12
    s_waitcnt lgkmcnt(0)
    buffer_load_dwordx4 v[112:115], v[28:29], s[12:15], 0 idxen offen
    buffer_load_dwordx4 v[116:119], v[30:31], s[12:15], 0 idxen offen
    buffer_load_dwordx4 v[120:123], v[32:33], s[12:15], 0 idxen offen
    buffer_load_dwordx4 v[124:127], v[34:35], s[12:15], 0 idxen offen
K2_BD12:
    s_bitcmp1_b32 s46, 12
    s_cbranch_scc1 K2_FL12
K2_NF12:
    ds_read_u16 v28, v9 offset:35584
    ds_read_u16 v30, v9 offset:35588
    ds_read_u16 v32, v9 offset:35592
    ds_read_u16 v34, v9 offset:35596
    ds_read_u16 v9, v7 offset:256
    ds_read_u16 v44, v7 offset:216
    v_mfma_f32_16x16x4_4b_f16 v[64:79], v[16:17], v[12:13], 4.0 cbsz:2 abid:1
    s_waitcnt vmcnt(8) lgkmcnt(6)
    v_fma_mix_f32 v40, v80, v48, v20 op_sel_hi:[1,0,0]
    v_fma_mix_f32 v41, v81, v52, v21 op_sel_hi:[1,0,0]
    v_fma_mix_f32 v42, v84, v49, v20 op_sel_hi:[1,0,0]
    v_fma_mix_f32 v43, v85, v53, v21 op_sel_hi:[1,0,0]
    v_fma_mix_f32 v48, v88, v50, v20 op_sel_hi:[1,0,0]
    v_fma_mix_f32 v49, v89, v54, v21 op_sel_hi:[1,0,0]
    v_fma_mix_f32 v52, v92, v51, v20 op_sel_hi:[1,0,0]
    v_fma_mix_f32 v53, v93, v55, v21 op_sel_hi:[1,0,0]
    v_mfma_f32_16x16x4_4b_f16 v[64:79], v[18:19], v[14:15], v[64:79] cbsz:2 abid:1
    v_fma_mix_f32 v50, v82, v56, v22 op_sel_hi:[1,0,0]
    v_fma_mix_f32 v51, v83, v60, v23 op_sel_hi:[1,0,0]
    v_fma_mix_f32 v54, v86, v57, v22 op_sel_hi:[1,0,0]
    v_fma_mix_f32 v55, v87, v61, v23 op_sel_hi:[1,0,0]
    v_fma_mix_f32 v56, v90, v58, v22 op_sel_hi:[1,0,0]
    v_fma_mix_f32 v57, v91, v62, v23 op_sel_hi:[1,0,0]
    v_fma_mix_f32 v60, v94, v59, v22 op_sel_hi:[1,0,0]
    v_fma_mix_f32 v61, v95, v63, v23 op_sel_hi:[1,0,0]
    v_pk_mul_f32 v[80:81], v[80:81], v[42:43]
    v_pk_mul_f32 v[82:83], v[82:83], v[54:55]
    v_pk_mul_f32 v[88:89], v[88:89], v[52:53]
    v_pk_mul_f32 v[90:91], v[90:91], v[60:61]
    v_pk_fma_f32 v[80:81], v[84:85], v[40:41], v[80:81]
    v_pk_fma_f32 v[82:83], v[86:87], v[50:51], v[82:83]
    v_pk_fma_f32 v[88:89], v[92:93], v[48:49], v[88:89]
    v_pk_fma_f32 v[90:91], v[94:95], v[56:57], v[90:91]
    v_pk_mul_f32 v[40:41], v[40:41], v[42:43]
    v_pk_mul_f32 v[50:51], v[50:51], v[54:55]
    v_pk_mul_f32 v[48:49], v[48:49], v[52:53]
    v_pk_mul_f32 v[56:57], v[56:57], v[60:61]
    v_pk_mul_f32 v[42:43], v[40:41], v[48:49]
    v_pk_mul_f32 v[54:55], v[50:51], v[56:57]
    v_rcp_f32 v52, v42
    v_rcp_f32 v53, v43
    v_rcp_f32 v60, v54
    v_rcp_f32 v61, v55
    v_pk_mul_f32 v[80:81], v[80:81], v[48:49]
    v_pk_mul_f32 v[82:83], v[82:83], v[56:57]
    v_pk_fma_f32 v[80:81], v[88:89], v[40:41], v[80:81]
    v_pk_fma_f32 v[82:83], v[90:91], v[50:51], v[82:83]
    v_pk_fma_f32 v[36:37], v[80:81], v[52:53], v[36:37]
    v_pk_fma_f32 v[38:39], v[82:83], v[60:61], v[38:39]
K2_IT13:
    s_cmp_le_u32 s40, 15
    s_cbranch_scc1 K2_TL13
    s_waitcnt lgkmcnt(0)
    buffer_load_dwordx4 v[80:83], v[28:29], s[12:15], 0 idxen offen
    buffer_load_dwordx4 v[84:87], v[30:31], s[12:15], 0 idxen offen
    buffer_load_dwordx4 v[88:91], v[32:33], s[12:15], 0 idxen offen
    buffer_load_dwordx4 v[92:95], v[34:35], s[12:15], 0 idxen offen
K2_BD13:
    s_bitcmp1_b32 s46, 13
    s_cbranch_scc1 K2_FL13
K2_NF13:
    ds_read_u16 v28, v9 offset:35584
    ds_read_u16 v30, v9 offset:35588
    ds_read_u16 v32, v9 offset:35592
    ds_read_u16 v34, v9 offset:35596
    ds_read_u16 v9, v7 offset:272
    ds_read_u16 v44, v7 offset:232
    ds_read_u16 v10, v8 offset:256
    v_mfma_f32_16x16x4_4b_f16 v[48:63], v[16:17], v[12:13], 4.0 cbsz:2 abid:2
    s_waitcnt vmcnt(8) lgkmcnt(7)
    v_fma_mix_f32 v40, v96, v64, v20 op_sel_hi:[1,0,0]
    v_fma_mix_f32 v41, v97, v68, v21 op_sel_hi:[1,0,0]
    v_fma_mix_f32 v42, v100, v65, v20 op_sel_hi:[1,0,0]
    v_fma_mix_f32 v43, v101, v69, v21 op_sel_hi:[1,0,0]
    v_fma_mix_f32 v64, v104, v66, v20 op_sel_hi:[1,0,0]
    v_fma_mix_f32 v65, v105, v70, v21 op_sel_hi:[1,0,0]
    v_fma_mix_f32 v68, v108, v67, v20 op_sel_hi:[1,0,0]
    v_fma_mix_f32 v69, v109, v71, v21 op_sel_hi:[1,0,0]
    v_mfma_f32_16x16x4_4b_f16 v[48:63], v[18:19], v[14:15], v[48:63] cbsz:2 abid:2
    v_fma_mix_f32 v66, v98, v72, v22 op_sel_hi:[1,0,0]
    v_fma_mix_f32 v67, v99, v76, v23 op_sel_hi:[1,0,0]
    v_fma_mix_f32 v70, v102, v73, v22 op_sel_hi:[1,0,0]
    v_fma_mix_f32 v71, v103, v77, v23 op_sel_hi:[1,0,0]
    v_fma_mix_f32 v72, v106, v74, v22 op_sel_hi:[1,0,0]
    v_fma_mix_f32 v73, v107, v78, v23 op_sel_hi:[1,0,0]
    v_fma_mix_f32 v76, v110, v75, v22 op_sel_hi:[1,0,0]
    v_fma_mix_f32 v77, v111, v79, v23 op_sel_hi:[1,0,0]
    v_pk_mul_f32 v[96:97], v[96:97], v[42:43]
    v_pk_mul_f32 v[98:99], v[98:99], v[70:71]
    v_pk_mul_f32 v[104:105], v[104:105], v[68:69]
    v_pk_mul_f32 v[106:107], v[106:107], v[76:77]
    v_pk_fma_f32 v[96:97], v[100:101], v[40:41], v[96:97]
    v_pk_fma_f32 v[98:99], v[102:103], v[66:67], v[98:99]
    v_pk_fma_f32 v[104:105], v[108:109], v[64:65], v[104:105]
    v_pk_fma_f32 v[106:107], v[110:111], v[72:73], v[106:107]
    v_pk_mul_f32 v[40:41], v[40:41], v[42:43]
    v_pk_mul_f32 v[66:67], v[66:67], v[70:71]
    v_pk_mul_f32 v[64:65], v[64:65], v[68:69]
    v_pk_mul_f32 v[72:73], v[72:73], v[76:77]
    v_pk_mul_f32 v[42:43], v[40:41], v[64:65]
    v_pk_mul_f32 v[70:71], v[66:67], v[72:73]
    v_rcp_f32 v68, v42
    v_rcp_f32 v69, v43
    v_rcp_f32 v76, v70
    v_rcp_f32 v77, v71
    v_pk_mul_f32 v[96:97], v[96:97], v[64:65]
    v_pk_mul_f32 v[98:99], v[98:99], v[72:73]
    v_pk_fma_f32 v[96:97], v[104:105], v[40:41], v[96:97]
    v_pk_fma_f32 v[98:99], v[106:107], v[66:67], v[98:99]
    v_pk_fma_f32 v[36:37], v[96:97], v[68:69], v[36:37]
    v_pk_fma_f32 v[38:39], v[98:99], v[76:77], v[38:39]
K2_IT14:
    s_cmp_le_u32 s40, 16
    s_cbranch_scc1 K2_TL14
    s_waitcnt lgkmcnt(0)
    buffer_load_dwordx4 v[96:99], v[28:29], s[12:15], 0 idxen offen
    buffer_load_dwordx4 v[100:103], v[30:31], s[12:15], 0 idxen offen
    buffer_load_dwordx4 v[104:107], v[32:33], s[12:15], 0 idxen offen
    buffer_load_dwordx4 v[108:111], v[34:35], s[12:15], 0 idxen offen
K2_BD14:
    s_bitcmp1_b32 s46, 14
    s_cbranch_scc1 K2_FL14
K2_NF14:
    ds_read_u16 v28, v9 offset:35584
    ds_read_u16 v30, v9 offset:35588
    ds_read_u16 v32, v9 offset:35592
    ds_read_u16 v34, v9 offset:35596
    ds_read_u16 v9, v7 offset:288
    ds_read_u16 v44, v7 offset:248
    ds_read_u16_d16_hi v27, v10 offset:35586
    v_mfma_f32_16x16x4_4b_f16 v[64:79], v[16:17], v[12:13], 4.0 cbsz:2 abid:3
    s_waitcnt vmcnt(8) lgkmcnt(7)
    v_fma_mix_f32 v40, v112, v48, v20 op_sel_hi:[1,0,0]
    v_fma_mix_f32 v41, v113, v52, v21 op_sel_hi:[1,0,0]
    v_fma_mix_f32 v42, v116, v49, v20 op_sel_hi:[1,0,0]
    v_fma_mix_f32 v43, v117, v53, v21 op_sel_hi:[1,0,0]
    v_fma_mix_f32 v48, v120, v50, v20 op_sel_hi:[1,0,0]
    v_fma_mix_f32 v49, v121, v54, v21 op_sel_hi:[1,0,0]
    v_fma_mix_f32 v52, v124, v51, v20 op_sel_hi:[1,0,0]
    v_fma_mix_f32 v53, v125, v55, v21 op_sel_hi:[1,0,0]
    v_mfma_f32_16x16x4_4b_f16 v[64:79], v[18:19], v[14:15], v[64:79] cbsz:2 abid:3
    v_fma_mix_f32 v50, v114, v56, v22 op_sel_hi:[1,0,0]
    v_fma_mix_f32 v51, v115, v60, v23 op_sel_hi:[1,0,0]
    v_fma_mix_f32 v54, v118, v57, v22 op_sel_hi:[1,0,0]
    v_fma_mix_f32 v55, v119, v61, v23 op_sel_hi:[1,0,0]
    v_fma_mix_f32 v56, v122, v58, v22 op_sel_hi:[1,0,0]
    v_fma_mix_f32 v57, v123, v62, v23 op_sel_hi:[1,0,0]
    v_fma_mix_f32 v60, v126, v59, v22 op_sel_hi:[1,0,0]
    v_fma_mix_f32 v61, v127, v63, v23 op_sel_hi:[1,0,0]
    v_pk_mul_f32 v[112:113], v[112:113], v[42:43]
    v_pk_mul_f32 v[114:115], v[114:115], v[54:55]
    v_pk_mul_f32 v[120:121], v[120:121], v[52:53]
    v_pk_mul_f32 v[122:123], v[122:123], v[60:61]
    v_pk_fma_f32 v[112:113], v[116:117], v[40:41], v[112:113]
    v_pk_fma_f32 v[114:115], v[118:119], v[50:51], v[114:115]
    v_pk_fma_f32 v[120:121], v[124:125], v[48:49], v[120:121]
    v_pk_fma_f32 v[122:123], v[126:127], v[56:57], v[122:123]
    v_pk_mul_f32 v[40:41], v[40:41], v[42:43]
    v_pk_mul_f32 v[50:51], v[50:51], v[54:55]
    v_pk_mul_f32 v[48:49], v[48:49], v[52:53]
    v_pk_mul_f32 v[56:57], v[56:57], v[60:61]
    v_pk_mul_f32 v[42:43], v[40:41], v[48:49]
    v_pk_mul_f32 v[54:55], v[50:51], v[56:57]
    v_rcp_f32 v52, v42
    v_rcp_f32 v53, v43
    v_rcp_f32 v60, v54
    v_rcp_f32 v61, v55
    v_pk_mul_f32 v[112:113], v[112:113], v[48:49]
    v_pk_mul_f32 v[114:115], v[114:115], v[56:57]
    v_pk_fma_f32 v[112:113], v[120:121], v[40:41], v[112:113]
    v_pk_fma_f32 v[114:115], v[122:123], v[50:51], v[114:115]
    v_pk_fma_f32 v[36:37], v[112:113], v[52:53], v[36:37]
    v_pk_fma_f32 v[38:39], v[114:115], v[60:61], v[38:39]
K2_MFIN:
    s_waitcnt lgkmcnt(0)
    ds_write_b128 v45, v[36:39]
    s_cmp_lg_u64 s[0:1], 0
    s_cbranch_scc1 K2_BADE
K2_MDONE2:
    v_lshrrev_b32 v40, 4, v0
    v_lshlrev_b32 v40, 3, v40
    v_lshlrev_b32 v46, 4, v0
    ds_read_b128 v[68:71], v46 offset:2816
    s_and_b32 s38, s30, 1
    s_add_u32 s38, s38, 1
    v_mov_b32 v24, 0
    s_mov_b32 s36, 0x3ffff
K2_RTL:
    ds_read_b64 v[42:43], v40 offset:256
    s_waitcnt lgkmcnt(0)
    v_and_b32 v44, v42, v43
    v_lshrrev_b32 v44, 24, v44
    v_cmp_ne_u32 vcc, s38, v44
    s_cbranch_vccnz K2_RTL
    v_and_or_b32 v47, v42, s36, v6
    v_and_or_b32 v48, v43, s36, v6
    v_bfe_u32 v49, v42, 18, 6
    v_bfe_u32 v50, v43, 18, 6
    v_mov_b64 v[64:65], 0
    v_mov_b64 v[66:67], 0
    v_mov_b64 v[80:81], 0
    v_mov_b64 v[82:83], 0
    v_mov_b64 v[84:85], 0
    v_mov_b64 v[86:87], 0
    v_mov_b64 v[88:89], 0
    v_mov_b64 v[90:91], 0
    v_mov_b64 v[92:93], 0
    v_mov_b64 v[94:95], 0
    v_mov_b64 v[96:97], 0
    v_mov_b64 v[98:99], 0
    v_cmp_lt_i32 s[24:25], 0, v49
    v_cmp_lt_i32 s[26:27], 1, v49
    v_cmp_lt_i32 s[32:33], 0, v50
    v_cmp_lt_i32 s[36:37], 1, v50
    v_cmp_lt_i32 s[44:45], 2, v50
    v_subrev_u32 v49, 2, v49
    v_subrev_u32 v50, 3, v50
    v_max_i32 v51, v49, v50
    v_cmp_lt_i32 vcc, 0, v51
    s_barrier
    ds_read_b128 v[40:43], v46 offset:19200
    ds_read_b128 v[72:75], v24 offset:0
K2_RED:
    s_mov_b64 exec, s[24:25]
    ds_read_b128 v[80:83], v47 offset:0
    s_mov_b64 exec, s[32:33]
    ds_read_b128 v[88:91], v48 offset:0
    s_mov_b64 exec, s[26:27]
    ds_read_b128 v[84:87], v47 offset:256
    s_mov_b64 exec, s[36:37]
    ds_read_b128 v[92:95], v48 offset:256
    s_mov_b64 exec, s[44:45]
    ds_read_b128 v[96:99], v48 offset:512
    s_mov_b64 exec, -1
    s_waitcnt lgkmcnt(3)
    v_or3_b32 v76, v72, v73, v74
    v_or_b32 v76, v76, v75
    v_pk_add_f32 v[80:81], v[80:81], v[88:89]
    v_pk_add_f32 v[82:83], v[82:83], v[90:91]
    v_readfirstlane_b32 s25, v76
    s_waitcnt lgkmcnt(1)
    v_pk_add_f32 v[84:85], v[84:85], v[92:93]
    v_pk_add_f32 v[86:87], v[86:87], v[94:95]
    v_pk_add_f32 v[64:65], v[64:65], v[80:81]
    v_pk_add_f32 v[66:67], v[66:67], v[82:83]
    s_waitcnt lgkmcnt(0)
    v_pk_add_f32 v[84:85], v[84:85], v[96:97]
    v_pk_add_f32 v[86:87], v[86:87], v[98:99]
    v_pk_add_f32 v[64:65], v[64:65], v[84:85]
    v_pk_add_f32 v[66:67], v[66:67], v[86:87]
    s_cbranch_vccnz K2_REDM
    s_or_b32 s25, s25, s31
    s_cbranch_scc1 K2_RARE
    v_pk_fma_f32 v[40:41], v[64:65], v[68:69], v[40:41]
    v_pk_fma_f32 v[42:43], v[66:67], v[70:71], v[42:43]
K2_FIN:
    v_lshlrev_b32 v24, 3, v0
    v_lshrrev_b32 v25, 4, v0
    s_lshl_b32 s25, s10, 7
    v_cmp_gt_u32 vcc, s11, v25
    v_mul_f32 v44, 0xbfb8aa3b, v40
    v_mul_f32 v45, 0xbfb8aa3b, v41
    v_mul_f32 v46, 0xbfb8aa3b, v42
    v_mul_f32 v47, 0xbfb8aa3b, v43
    v_exp_f32 v44, v44
    v_exp_f32 v45, v45
    v_exp_f32 v46, v46
    v_exp_f32 v47, v47
    v_add_f32 v44, 1.0, v44
    v_add_f32 v45, 1.0, v45
    v_add_f32 v46, 1.0, v46
    v_add_f32 v47, 1.0, v47
    v_rcp_f32 v44, v44
    v_rcp_f32 v45, v45
    v_rcp_f32 v46, v46
    v_rcp_f32 v47, v47
    v_mul_f32 v40, v40, v44
    v_mul_f32 v41, v41, v45
    v_mul_f32 v42, v42, v46
    v_mul_f32 v43, v43, v47
    v_cvt_pk_bf16_f32 v44, v40, v41
    v_cvt_pk_bf16_f32 v45, v42, v43
    s_and_b64 exec, exec, vcc
    s_cbranch_execz K2_END0
    buffer_store_dwordx2 v[44:45], v24, s[20:23], s25 offen sc1
K2_END0:
K2_END:
    s_endpgm
K2_TL0:
    s_waitcnt vmcnt(4) lgkmcnt(0)
    s_cmp_eq_u32 s40, 2
    s_cbranch_scc1 K2_BD0
    s_waitcnt vmcnt(0) lgkmcnt(0)
    s_branch K2_BD0
K2_TL1:
    s_cmp_eq_u32 s40, 1
    s_cbranch_scc1 K2_MFIN
    s_waitcnt vmcnt(4) lgkmcnt(0)
    s_cmp_eq_u32 s40, 3
    s_cbranch_scc1 K2_BD1
    s_waitcnt vmcnt(0) lgkmcnt(0)
    s_branch K2_BD1
K2_FL1:
    ds_write_b128 v45, v[36:39]
    v_add_u32 v25, v44, v6
    v_add_u32 v24, v44, v46
    ds_read_b128 v[20:23], v25 offset:2816
    v_cmp_ne_u32 vcc, v24, v45
    v_mov_b32 v45, v24
    s_mov_b64 exec, vcc
    v_mov_b64 v[36:37], 0
    v_mov_b64 v[38:39], 0
    s_mov_b64 exec, -1
    s_branch K2_NF1
K2_TL2:
    s_cmp_eq_u32 s40, 2
    s_cbranch_scc1 K2_MFIN
    s_waitcnt vmcnt(4) lgkmcnt(0)
    s_cmp_eq_u32 s40, 4
    s_cbranch_scc1 K2_BD2
    s_waitcnt vmcnt(0) lgkmcnt(0)
    s_branch K2_BD2
K2_FL2:
    ds_write_b128 v45, v[36:39]
    v_add_u32 v25, v44, v6
    v_add_u32 v24, v44, v46
    ds_read_b128 v[20:23], v25 offset:2816
    v_cmp_ne_u32 vcc, v24, v45
    v_mov_b32 v45, v24
    s_mov_b64 exec, vcc
    v_mov_b64 v[36:37], 0
    v_mov_b64 v[38:39], 0
    s_mov_b64 exec, -1
    s_branch K2_NF2
K2_TL3:
    s_cmp_eq_u32 s40, 3
    s_cbranch_scc1 K2_MFIN
    s_waitcnt vmcnt(4) lgkmcnt(0)
    s_cmp_eq_u32 s40, 5
    s_cbranch_scc1 K2_BD3
    s_waitcnt vmcnt(0) lgkmcnt(0)
    s_branch K2_BD3
K2_FL3:
    ds_write_b128 v45, v[36:39]
    v_add_u32 v25, v44, v6
    v_add_u32 v24, v44, v46
    ds_read_b128 v[20:23], v25 offset:2816
    v_cmp_ne_u32 vcc, v24, v45
    v_mov_b32 v45, v24
    s_mov_b64 exec, vcc
    v_mov_b64 v[36:37], 0
    v_mov_b64 v[38:39], 0
    s_mov_b64 exec, -1
    s_branch K2_NF3
K2_TL4:
    s_cmp_eq_u32 s40, 4
    s_cbranch_scc1 K2_MFIN
    s_waitcnt vmcnt(4) lgkmcnt(0)
    s_cmp_eq_u32 s40, 6
    s_cbranch_scc1 K2_BD4
    s_waitcnt vmcnt(0) lgkmcnt(0)
    s_branch K2_BD4
K2_FL4:
    ds_write_b128 v45, v[36:39]
    v_add_u32 v25, v44, v6
    v_add_u32 v24, v44, v46
    ds_read_b128 v[20:23], v25 offset:2816
    v_cmp_ne_u32 vcc, v24, v45
    v_mov_b32 v45, v24
    s_mov_b64 exec, vcc
    v_mov_b64 v[36:37], 0
    v_mov_b64 v[38:39], 0
    s_mov_b64 exec, -1
    s_branch K2_NF4
K2_TL5:
    s_cmp_eq_u32 s40, 5
    s_cbranch_scc1 K2_MFIN
    s_waitcnt vmcnt(4) lgkmcnt(0)
    s_cmp_eq_u32 s40, 7
    s_cbranch_scc1 K2_BD5
    s_waitcnt vmcnt(0) lgkmcnt(0)
    s_branch K2_BD5
K2_FL5:
    ds_write_b128 v45, v[36:39]
    v_add_u32 v25, v44, v6
    v_add_u32 v24, v44, v46
    ds_read_b128 v[20:23], v25 offset:2816
    v_cmp_ne_u32 vcc, v24, v45
    v_mov_b32 v45, v24
    s_mov_b64 exec, vcc
    v_mov_b64 v[36:37], 0
    v_mov_b64 v[38:39], 0
    s_mov_b64 exec, -1
    s_branch K2_NF5
K2_TL6:
    s_cmp_eq_u32 s40, 6
    s_cbranch_scc1 K2_MFIN
    s_waitcnt vmcnt(4) lgkmcnt(0)
    s_cmp_eq_u32 s40, 8
    s_cbranch_scc1 K2_BD6
    s_waitcnt vmcnt(0) lgkmcnt(0)
    s_branch K2_BD6
K2_FL6:
    ds_write_b128 v45, v[36:39]
    v_add_u32 v25, v44, v6
    v_add_u32 v24, v44, v46
    ds_read_b128 v[20:23], v25 offset:2816
    v_cmp_ne_u32 vcc, v24, v45
    v_mov_b32 v45, v24
    s_mov_b64 exec, vcc
    v_mov_b64 v[36:37], 0
    v_mov_b64 v[38:39], 0
    s_mov_b64 exec, -1
    s_branch K2_NF6
K2_TL7:
    s_cmp_eq_u32 s40, 7
    s_cbranch_scc1 K2_MFIN
    s_waitcnt vmcnt(4) lgkmcnt(0)
    s_cmp_eq_u32 s40, 9
    s_cbranch_scc1 K2_BD7
    s_waitcnt vmcnt(0) lgkmcnt(0)
    s_branch K2_BD7
K2_FL7:
    ds_write_b128 v45, v[36:39]
    v_add_u32 v25, v44, v6
    v_add_u32 v24, v44, v46
    ds_read_b128 v[20:23], v25 offset:2816
    v_cmp_ne_u32 vcc, v24, v45
    v_mov_b32 v45, v24
    s_mov_b64 exec, vcc
    v_mov_b64 v[36:37], 0
    v_mov_b64 v[38:39], 0
    s_mov_b64 exec, -1
    s_branch K2_NF7
K2_TL8:
    s_cmp_eq_u32 s40, 8
    s_cbranch_scc1 K2_MFIN
    s_waitcnt vmcnt(4) lgkmcnt(0)
    s_cmp_eq_u32 s40, 10
    s_cbranch_scc1 K2_BD8
    s_waitcnt vmcnt(0) lgkmcnt(0)
    s_branch K2_BD8
K2_FL8:
    ds_write_b128 v45, v[36:39]
    v_add_u32 v25, v44, v6
    v_add_u32 v24, v44, v46
    ds_read_b128 v[20:23], v25 offset:2816
    v_cmp_ne_u32 vcc, v24, v45
    v_mov_b32 v45, v24
    s_mov_b64 exec, vcc
    v_mov_b64 v[36:37], 0
    v_mov_b64 v[38:39], 0
    s_mov_b64 exec, -1
    s_branch K2_NF8
K2_TL9:
    s_cmp_eq_u32 s40, 9
    s_cbranch_scc1 K2_MFIN
    s_waitcnt vmcnt(4) lgkmcnt(0)
    s_cmp_eq_u32 s40, 11
    s_cbranch_scc1 K2_BD9
    s_waitcnt vmcnt(0) lgkmcnt(0)
    s_branch K2_BD9
K2_FL9:
    ds_write_b128 v45, v[36:39]
    v_add_u32 v25, v44, v6
    v_add_u32 v24, v44, v46
    ds_read_b128 v[20:23], v25 offset:2816
    v_cmp_ne_u32 vcc, v24, v45
    v_mov_b32 v45, v24
    s_mov_b64 exec, vcc
    v_mov_b64 v[36:37], 0
    v_mov_b64 v[38:39], 0
    s_mov_b64 exec, -1
    s_branch K2_NF9
K2_TL10:
    s_cmp_eq_u32 s40, 10
    s_cbranch_scc1 K2_MFIN
    s_waitcnt vmcnt(4) lgkmcnt(0)
    s_cmp_eq_u32 s40, 12
    s_cbranch_scc1 K2_BD10
    s_waitcnt vmcnt(0) lgkmcnt(0)
    s_branch K2_BD10
K2_FL10:
    ds_write_b128 v45, v[36:39]
    v_add_u32 v25, v44, v6
    v_add_u32 v24, v44, v46
    ds_read_b128 v[20:23], v25 offset:2816
    v_cmp_ne_u32 vcc, v24, v45
    v_mov_b32 v45, v24
    s_mov_b64 exec, vcc
    v_mov_b64 v[36:37], 0
    v_mov_b64 v[38:39], 0
    s_mov_b64 exec, -1
    s_branch K2_NF10
K2_TL11:
    s_cmp_eq_u32 s40, 11
    s_cbranch_scc1 K2_MFIN
    s_waitcnt vmcnt(4) lgkmcnt(0)
    s_cmp_eq_u32 s40, 13
    s_cbranch_scc1 K2_BD11
    s_waitcnt vmcnt(0) lgkmcnt(0)
    s_branch K2_BD11
K2_FL11:
    ds_write_b128 v45, v[36:39]
    v_add_u32 v25, v44, v6
    v_add_u32 v24, v44, v46
    ds_read_b128 v[20:23], v25 offset:2816
    v_cmp_ne_u32 vcc, v24, v45
    v_mov_b32 v45, v24
    s_mov_b64 exec, vcc
    v_mov_b64 v[36:37], 0
    v_mov_b64 v[38:39], 0
    s_mov_b64 exec, -1
    s_branch K2_NF11
K2_TL12:
    s_cmp_eq_u32 s40, 12
    s_cbranch_scc1 K2_MFIN
    s_waitcnt vmcnt(4) lgkmcnt(0)
    s_cmp_eq_u32 s40, 14
    s_cbranch_scc1 K2_BD12
    s_waitcnt vmcnt(0) lgkmcnt(0)
    s_branch K2_BD12
K2_FL12:
    ds_write_b128 v45, v[36:39]
    v_add_u32 v25, v44, v6
    v_add_u32 v24, v44, v46
    ds_read_b128 v[20:23], v25 offset:2816
    v_cmp_ne_u32 vcc, v24, v45
    v_mov_b32 v45, v24
    s_mov_b64 exec, vcc
    v_mov_b64 v[36:37], 0
    v_mov_b64 v[38:39], 0
    s_mov_b64 exec, -1
    s_branch K2_NF12
K2_TL13:
    s_cmp_eq_u32 s40, 13
    s_cbranch_scc1 K2_MFIN
    s_waitcnt vmcnt(4) lgkmcnt(0)
    s_cmp_eq_u32 s40, 15
    s_cbranch_scc1 K2_BD13
    s_waitcnt vmcnt(0) lgkmcnt(0)
    s_branch K2_BD13
K2_FL13:
    ds_write_b128 v45, v[36:39]
    v_add_u32 v25, v44, v6
    v_add_u32 v24, v44, v46
    ds_read_b128 v[20:23], v25 offset:2816
    v_cmp_ne_u32 vcc, v24, v45
    v_mov_b32 v45, v24
    s_mov_b64 exec, vcc
    v_mov_b64 v[36:37], 0
    v_mov_b64 v[38:39], 0
    s_mov_b64 exec, -1
    s_branch K2_NF13
K2_TL14:
    s_cmp_eq_u32 s40, 14
    s_cbranch_scc1 K2_MFIN
    s_waitcnt vmcnt(4) lgkmcnt(0)
    s_cmp_eq_u32 s40, 16
    s_cbranch_scc1 K2_BD14
    s_waitcnt vmcnt(0) lgkmcnt(0)
    s_branch K2_BD14
K2_FL14:
    ds_write_b128 v45, v[36:39]
    v_add_u32 v25, v44, v6
    v_add_u32 v24, v44, v46
    ds_read_b128 v[20:23], v25 offset:2816
    v_cmp_ne_u32 vcc, v24, v45
    v_mov_b32 v45, v24
    s_mov_b64 exec, vcc
    v_mov_b64 v[36:37], 0
    v_mov_b64 v[38:39], 0
    s_mov_b64 exec, -1
    s_branch K2_NF14
K2_BADE:
    v_mov_b32 v24, 0
    v_mov_b32 v25, 1
    ds_write_b32 v24, v25 offset:0
K2_MDONE:
    s_waitcnt lgkmcnt(0)
    s_branch K2_MDONE2
K2_REDM:
    v_add_u32 v47, 512, v47
    v_add_u32 v48, 768, v48
    v_mov_b64 v[80:81], 0
    v_mov_b64 v[82:83], 0
    v_mov_b64 v[84:85], 0
    v_mov_b64 v[86:87], 0
    v_mov_b64 v[88:89], 0
    v_mov_b64 v[90:91], 0
    v_mov_b64 v[92:93], 0
    v_mov_b64 v[94:95], 0
    v_mov_b64 v[96:97], 0
    v_mov_b64 v[98:99], 0
    v_cmp_lt_i32 s[24:25], 0, v49
    v_cmp_lt_i32 s[26:27], 1, v49
    v_cmp_lt_i32 s[32:33], 0, v50
    v_cmp_lt_i32 s[36:37], 1, v50
    v_cmp_lt_i32 s[44:45], 2, v50
    v_subrev_u32 v49, 2, v49
    v_subrev_u32 v50, 3, v50
    v_max_i32 v51, v49, v50
    v_cmp_lt_i32 vcc, 0, v51
    s_nop 3
    s_branch K2_RED
K2_DMA:
    v_lshlrev_b32 v25, 4, v1
    v_lshrrev_b32 v26, 3, v1
    v_and_b32 v9, 7, v0
    v_xor_b32 v9, v9, v26
    s_lshl4_add_u32 s36, s28, s10
    s_add_u32 s27, s10, 48
    s_min_u32 s27, s27, 12499
    v_add_u32 v26, s36, v26
    v_min_u32 v7, s27, v26
    s_sub_u32 s27, s27, 8
    v_min_u32 v26, s27, v26
    v_lshlrev_b32 v9, 4, v9
    v_lshl_add_u32 v7, v7, 7, v9
    v_lshl_add_u32 v26, v26, 7, v9
    s_lshl_b32 s36, s28, 11
    s_lshl_b32 s26, s28, 12
    s_add_u32 s27, s26, 129536
    s_add_u32 s26, s26, 0x380000
    s_mov_b32 m0, s27
    s_add_u32 s27, s36, 145920
    s_waitcnt lgkmcnt(0)
    s_mov_b32 s16, s8
    s_and_b32 s17, s9, 0xffff
    s_mov_b32 s18, 0x1f00000
    s_mov_b32 s19, 0x20000
    buffer_load_dwordx4 v25, s[16:19], s26 offen offset:0 lds
    buffer_load_dwordx4 v25, s[16:19], s26 offen offset:1024 lds
    buffer_load_dwordx4 v25, s[16:19], s26 offen offset:2048 lds
    buffer_load_dwordx4 v25, s[16:19], s26 offen offset:3072 lds
    s_mov_b32 s56, s56
    s_and_b32 s57, s57, 0xffff
    s_mov_b32 s58, 0x186a00
    s_mov_b32 s59, 0x20000
    s_mov_b32 m0, s27
    s_lshl_b32 s36, s28, 10
    s_movk_i32 s37, 2624
    s_add_u32 s27, s36, 104448
    s_add_u32 s26, s36, 0x384000
    buffer_load_dwordx4 v7, s[56:59], 0 offen lds
    buffer_load_dwordx4 v26, s[56:59], 0 offen offset:1024 lds
    s_mov_b32 m0, s27
    s_cmp_ge_u32 s28, 3
    s_cbranch_scc1 K2_NDMB
    v_add_u32 v26, s36, v25
    v_cmp_ge_u32_e64 s[32:33], s37, v26
    s_mov_b64 exec, s[32:33]
    buffer_load_dwordx4 v25, s[16:19], s26 offen lds
    s_mov_b64 exec, -1
    s_branch K2_NDMB
K2_PUB:
    s_add_u32 s44, s42, 1
    s_max_u32 s45, s42, 1
    v_cvt_f32_u32 v56, s44
    v_cvt_f32_u32 v57, s45
    v_rcp_f32 v56, v56
    v_rcp_f32 v57, v57
    s_mul_i32 s25, s43, s44
    s_lshl_b32 s25, s25, 2
    s_lshl_b32 s26, s43, 2
    v_mul_f32 v56, 0x49800000, v56
    v_mul_f32 v57, 0x49800000, v57
    v_cvt_u32_f32 v56, v56
    v_cvt_u32_f32 v57, v57
    v_add_u32 v56, 2, v56
    v_add_u32 v57, 2, v57
    v_add3_u32 v58, v4, v5, -1
    v_mul_u32_u24 v59, v4, v56
    v_lshrrev_b32 v59, 20, v59
    v_subrev_u32 v60, s25, v4
    v_mul_u32_u24 v60, v60, v57
    v_lshrrev_b32 v60, 20, v60
    v_add_u32 v60, s26, v60
    v_cmp_gt_u32 vcc, s25, v4
    s_nop 1
    v_cndmask_b32 v59, v60, v59, vcc
    v_mul_u32_u24 v61, v58, v56
    v_lshrrev_b32 v61, 20, v61
    v_subrev_u32 v60, s25, v58
    v_mul_u32_u24 v60, v60, v57
    v_lshrrev_b32 v60, 20, v60
    v_add_u32 v60, s26, v60
    v_cmp_gt_u32 vcc, s25, v58
    s_nop 1
    v_cndmask_b32 v61, v60, v61, vcc
    v_sub_u32 v61, v61, v59
    v_add_u32 v61, 1, v61
    v_cmp_ne_u32 vcc, 0, v5
    s_nop 1
    v_cndmask_b32 v61, 0, v61, vcc
    v_cndmask_b32 v59, 0, v59, vcc
    v_add_u32 v59, v59, v1
    s_mul_i32 s25, s29, 16896
    s_and_b32 s26, s30, 1
    s_add_u32 s26, s26, 1
    s_lshl_b32 s26, s26, 24
    s_add_u32 s25, s25, s26
    s_add_u32 s25, s25, 112640
    v_lshl_add_u32 v59, v59, 8, s25
    v_lshl_or_b32 v59, v61, 18, v59
    s_lshl_b32 s26, s29, 2
    v_lshl_add_u32 v60, v1, 3, s26
    ds_write_b32 v60, v59 offset:256
    s_branch K2_PUBD
K2_NOG1:
    s_cmp_eq_u32 s40, 0
    s_cbranch_scc1 K2_NOG0
    s_waitcnt lgkmcnt(0)
    buffer_load_dwordx4 v[80:83], v[28:29], s[12:15], 0 idxen offen
    buffer_load_dwordx4 v[84:87], v[30:31], s[12:15], 0 idxen offen
    buffer_load_dwordx4 v[88:91], v[32:33], s[12:15], 0 idxen offen
    buffer_load_dwordx4 v[92:95], v[34:35], s[12:15], 0 idxen offen
K2_NOG0:
    s_waitcnt vmcnt(0)
    s_branch K2_G0D
K2_MAIN_S:
    s_waitcnt vmcnt(0) lgkmcnt(0)
    v_mov_b32 v40, 0
    v_mov_b32 v41, 0
    v_mov_b32 v42, 0
    v_mov_b32 v43, 0
K2_SLP:
    ds_read_u16 v9, v7
    ds_read_u16 v44, v7 offset:8
    v_add_u32 v7, 16, v7
    s_waitcnt lgkmcnt(0)
    ds_read_u16 v28, v9 offset:35584
    ds_read_u16 v30, v9 offset:35588
    ds_read_u16 v32, v9 offset:35592
    ds_read_u16 v34, v9 offset:35596
    ds_read_u16_d16_hi v40, v9 offset:35586
    ds_read_u16_d16_hi v41, v9 offset:35590
    ds_read_u16_d16_hi v42, v9 offset:35594
    ds_read_u16_d16_hi v43, v9 offset:35598
    v_add_u32 v25, v44, v6
    v_add_u32 v24, v44, v46
    ds_read_b128 v[20:23], v25 offset:2816
    v_cmp_ne_u32 vcc, v24, v45
    v_mov_b32 v45, v24
    s_mov_b64 exec, vcc
    v_mov_b64 v[36:37], 0
    v_mov_b64 v[38:39], 0
    s_mov_b64 exec, -1
    s_waitcnt lgkmcnt(5)
    buffer_load_dwordx4 v[80:83], v[28:29], s[12:15], 0 idxen offen
    buffer_load_dwordx4 v[84:87], v[30:31], s[12:15], 0 idxen offen
    buffer_load_dwordx4 v[88:91], v[32:33], s[12:15], 0 idxen offen
    buffer_load_dwordx4 v[92:95], v[34:35], s[12:15], 0 idxen offen
    s_waitcnt vmcnt(0) lgkmcnt(0)
    v_cvt_f32_f16 v48, v80
    v_and_b32 v64, 0x3fff, v80
    v_or_b32 v64, 0x4000, v64
    v_cvt_f32_f16 v64, v64
    v_lshlrev_b32 v25, 17, v80
    v_and_b32 v25, 0x80000000, v25
    v_mul_f32 v64, 4.0, v64
    v_xor_b32 v64, v64, v25
    v_log_f32 v48, v48
    v_and_b32 v25, 0x8000, v80
    v_cmp_ne_u32 vcc, 0, v25
    v_max_f32 v48, 0xf149f2ca, v48
    s_nop 0
    v_cndmask_b32 v48, v48, v64, vcc
    v_fmac_f32 v48, v40, v12
    v_add_f32 v48, v48, v20
    v_exp_f32 v48, v48
    s_nop 0
    v_add_f32 v48, 1.0, v48
    v_rcp_f32 v48, v48
    v_cvt_f32_f16 v49, v81
    v_and_b32 v65, 0x3fff, v81
    v_or_b32 v65, 0x4000, v65
    v_cvt_f32_f16 v65, v65
    v_lshlrev_b32 v25, 17, v81
    v_and_b32 v25, 0x80000000, v25
    v_mul_f32 v65, 4.0, v65
    v_xor_b32 v65, v65, v25
    v_log_f32 v49, v49
    v_and_b32 v25, 0x8000, v81
    v_cmp_ne_u32 vcc, 0, v25
    v_max_f32 v49, 0xf149f2ca, v49
    s_nop 0
    v_cndmask_b32 v49, v49, v65, vcc
    v_fmac_f32 v49, v40, v13
    v_add_f32 v49, v49, v21
    v_exp_f32 v49, v49
    s_nop 0
    v_add_f32 v49, 1.0, v49
    v_rcp_f32 v49, v49
    v_cvt_f32_f16 v50, v82
    v_and_b32 v66, 0x3fff, v82
    v_or_b32 v66, 0x4000, v66
    v_cvt_f32_f16 v66, v66
    v_lshlrev_b32 v25, 17, v82
    v_and_b32 v25, 0x80000000, v25
    v_mul_f32 v66, 4.0, v66
    v_xor_b32 v66, v66, v25
    v_log_f32 v50, v50
    v_and_b32 v25, 0x8000, v82
    v_cmp_ne_u32 vcc, 0, v25
    v_max_f32 v50, 0xf149f2ca, v50
    s_nop 0
    v_cndmask_b32 v50, v50, v66, vcc
    v_fmac_f32 v50, v40, v14
    v_add_f32 v50, v50, v22
    v_exp_f32 v50, v50
    s_nop 0
    v_add_f32 v50, 1.0, v50
    v_rcp_f32 v50, v50
    v_cvt_f32_f16 v51, v83
    v_and_b32 v67, 0x3fff, v83
    v_or_b32 v67, 0x4000, v67
    v_cvt_f32_f16 v67, v67
    v_lshlrev_b32 v25, 17, v83
    v_and_b32 v25, 0x80000000, v25
    v_mul_f32 v67, 4.0, v67
    v_xor_b32 v67, v67, v25
    v_log_f32 v51, v51
    v_and_b32 v25, 0x8000, v83
    v_cmp_ne_u32 vcc, 0, v25
    v_max_f32 v51, 0xf149f2ca, v51
    s_nop 0
    v_cndmask_b32 v51, v51, v67, vcc
    v_fmac_f32 v51, v40, v15
    v_add_f32 v51, v51, v23
    v_exp_f32 v51, v51
    s_nop 0
    v_add_f32 v51, 1.0, v51
    v_rcp_f32 v51, v51
    v_cvt_f32_f16 v52, v84
    v_and_b32 v68, 0x3fff, v84
    v_or_b32 v68, 0x4000, v68
    v_cvt_f32_f16 v68, v68
    v_lshlrev_b32 v25, 17, v84
    v_and_b32 v25, 0x80000000, v25
    v_mul_f32 v68, 4.0, v68
    v_xor_b32 v68, v68, v25
    v_log_f32 v52, v52
    v_and_b32 v25, 0x8000, v84
    v_cmp_ne_u32 vcc, 0, v25
    v_max_f32 v52, 0xf149f2ca, v52
    s_nop 0
    v_cndmask_b32 v52, v52, v68, vcc
    v_fmac_f32 v52, v41, v12
    v_add_f32 v52, v52, v20
    v_exp_f32 v52, v52
    s_nop 0
    v_add_f32 v52, 1.0, v52
    v_rcp_f32 v52, v52
    v_cvt_f32_f16 v53, v85
    v_and_b32 v69, 0x3fff, v85
    v_or_b32 v69, 0x4000, v69
    v_cvt_f32_f16 v69, v69
    v_lshlrev_b32 v25, 17, v85
    v_and_b32 v25, 0x80000000, v25
    v_mul_f32 v69, 4.0, v69
    v_xor_b32 v69, v69, v25
    v_log_f32 v53, v53
    v_and_b32 v25, 0x8000, v85
    v_cmp_ne_u32 vcc, 0, v25
    v_max_f32 v53, 0xf149f2ca, v53
    s_nop 0
    v_cndmask_b32 v53, v53, v69, vcc
    v_fmac_f32 v53, v41, v13
    v_add_f32 v53, v53, v21
    v_exp_f32 v53, v53
    s_nop 0
    v_add_f32 v53, 1.0, v53
    v_rcp_f32 v53, v53
    v_cvt_f32_f16 v54, v86
    v_and_b32 v70, 0x3fff, v86
    v_or_b32 v70, 0x4000, v70
    v_cvt_f32_f16 v70, v70
    v_lshlrev_b32 v25, 17, v86
    v_and_b32 v25, 0x80000000, v25
    v_mul_f32 v70, 4.0, v70
    v_xor_b32 v70, v70, v25
    v_log_f32 v54, v54
    v_and_b32 v25, 0x8000, v86
    v_cmp_ne_u32 vcc, 0, v25
    v_max_f32 v54, 0xf149f2ca, v54
    s_nop 0
    v_cndmask_b32 v54, v54, v70, vcc
    v_fmac_f32 v54, v41, v14
    v_add_f32 v54, v54, v22
    v_exp_f32 v54, v54
    s_nop 0
    v_add_f32 v54, 1.0, v54
    v_rcp_f32 v54, v54
    v_cvt_f32_f16 v55, v87
    v_and_b32 v71, 0x3fff, v87
    v_or_b32 v71, 0x4000, v71
    v_cvt_f32_f16 v71, v71
    v_lshlrev_b32 v25, 17, v87
    v_and_b32 v25, 0x80000000, v25
    v_mul_f32 v71, 4.0, v71
    v_xor_b32 v71, v71, v25
    v_log_f32 v55, v55
    v_and_b32 v25, 0x8000, v87
    v_cmp_ne_u32 vcc, 0, v25
    v_max_f32 v55, 0xf149f2ca, v55
    s_nop 0
    v_cndmask_b32 v55, v55, v71, vcc
    v_fmac_f32 v55, v41, v15
    v_add_f32 v55, v55, v23
    v_exp_f32 v55, v55
    s_nop 0
    v_add_f32 v55, 1.0, v55
    v_rcp_f32 v55, v55
    v_cvt_f32_f16 v56, v88
    v_and_b32 v72, 0x3fff, v88
    v_or_b32 v72, 0x4000, v72
    v_cvt_f32_f16 v72, v72
    v_lshlrev_b32 v25, 17, v88
    v_and_b32 v25, 0x80000000, v25
    v_mul_f32 v72, 4.0, v72
    v_xor_b32 v72, v72, v25
    v_log_f32 v56, v56
    v_and_b32 v25, 0x8000, v88
    v_cmp_ne_u32 vcc, 0, v25
    v_max_f32 v56, 0xf149f2ca, v56
    s_nop 0
    v_cndmask_b32 v56, v56, v72, vcc
    v_fmac_f32 v56, v42, v12
    v_add_f32 v56, v56, v20
    v_exp_f32 v56, v56
    s_nop 0
    v_add_f32 v56, 1.0, v56
    v_rcp_f32 v56, v56
    v_cvt_f32_f16 v57, v89
    v_and_b32 v73, 0x3fff, v89
    v_or_b32 v73, 0x4000, v73
    v_cvt_f32_f16 v73, v73
    v_lshlrev_b32 v25, 17, v89
    v_and_b32 v25, 0x80000000, v25
    v_mul_f32 v73, 4.0, v73
    v_xor_b32 v73, v73, v25
    v_log_f32 v57, v57
    v_and_b32 v25, 0x8000, v89
    v_cmp_ne_u32 vcc, 0, v25
    v_max_f32 v57, 0xf149f2ca, v57
    s_nop 0
    v_cndmask_b32 v57, v57, v73, vcc
    v_fmac_f32 v57, v42, v13
    v_add_f32 v57, v57, v21
    v_exp_f32 v57, v57
    s_nop 0
    v_add_f32 v57, 1.0, v57
    v_rcp_f32 v57, v57
    v_cvt_f32_f16 v58, v90
    v_and_b32 v74, 0x3fff, v90
    v_or_b32 v74, 0x4000, v74
    v_cvt_f32_f16 v74, v74
    v_lshlrev_b32 v25, 17, v90
    v_and_b32 v25, 0x80000000, v25
    v_mul_f32 v74, 4.0, v74
    v_xor_b32 v74, v74, v25
    v_log_f32 v58, v58
    v_and_b32 v25, 0x8000, v90
    v_cmp_ne_u32 vcc, 0, v25
    v_max_f32 v58, 0xf149f2ca, v58
    s_nop 0
    v_cndmask_b32 v58, v58, v74, vcc
    v_fmac_f32 v58, v42, v14
    v_add_f32 v58, v58, v22
    v_exp_f32 v58, v58
    s_nop 0
    v_add_f32 v58, 1.0, v58
    v_rcp_f32 v58, v58
    v_cvt_f32_f16 v59, v91
    v_and_b32 v75, 0x3fff, v91
    v_or_b32 v75, 0x4000, v75
    v_cvt_f32_f16 v75, v75
    v_lshlrev_b32 v25, 17, v91
    v_and_b32 v25, 0x80000000, v25
    v_mul_f32 v75, 4.0, v75
    v_xor_b32 v75, v75, v25
    v_log_f32 v59, v59
    v_and_b32 v25, 0x8000, v91
    v_cmp_ne_u32 vcc, 0, v25
    v_max_f32 v59, 0xf149f2ca, v59
    s_nop 0
    v_cndmask_b32 v59, v59, v75, vcc
    v_fmac_f32 v59, v42, v15
    v_add_f32 v59, v59, v23
    v_exp_f32 v59, v59
    s_nop 0
    v_add_f32 v59, 1.0, v59
    v_rcp_f32 v59, v59
    v_cvt_f32_f16 v60, v92
    v_and_b32 v76, 0x3fff, v92
    v_or_b32 v76, 0x4000, v76
    v_cvt_f32_f16 v76, v76
    v_lshlrev_b32 v25, 17, v92
    v_and_b32 v25, 0x80000000, v25
    v_mul_f32 v76, 4.0, v76
    v_xor_b32 v76, v76, v25
    v_log_f32 v60, v60
    v_and_b32 v25, 0x8000, v92
    v_cmp_ne_u32 vcc, 0, v25
    v_max_f32 v60, 0xf149f2ca, v60
    s_nop 0
    v_cndmask_b32 v60, v60, v76, vcc
    v_fmac_f32 v60, v43, v12
    v_add_f32 v60, v60, v20
    v_exp_f32 v60, v60
    s_nop 0
    v_add_f32 v60, 1.0, v60
    v_rcp_f32 v60, v60
    v_cvt_f32_f16 v61, v93
    v_and_b32 v77, 0x3fff, v93
    v_or_b32 v77, 0x4000, v77
    v_cvt_f32_f16 v77, v77
    v_lshlrev_b32 v25, 17, v93
    v_and_b32 v25, 0x80000000, v25
    v_mul_f32 v77, 4.0, v77
    v_xor_b32 v77, v77, v25
    v_log_f32 v61, v61
    v_and_b32 v25, 0x8000, v93
    v_cmp_ne_u32 vcc, 0, v25
    v_max_f32 v61, 0xf149f2ca, v61
    s_nop 0
    v_cndmask_b32 v61, v61, v77, vcc
    v_fmac_f32 v61, v43, v13
    v_add_f32 v61, v61, v21
    v_exp_f32 v61, v61
    s_nop 0
    v_add_f32 v61, 1.0, v61
    v_rcp_f32 v61, v61
    v_cvt_f32_f16 v62, v94
    v_and_b32 v78, 0x3fff, v94
    v_or_b32 v78, 0x4000, v78
    v_cvt_f32_f16 v78, v78
    v_lshlrev_b32 v25, 17, v94
    v_and_b32 v25, 0x80000000, v25
    v_mul_f32 v78, 4.0, v78
    v_xor_b32 v78, v78, v25
    v_log_f32 v62, v62
    v_and_b32 v25, 0x8000, v94
    v_cmp_ne_u32 vcc, 0, v25
    v_max_f32 v62, 0xf149f2ca, v62
    s_nop 0
    v_cndmask_b32 v62, v62, v78, vcc
    v_fmac_f32 v62, v43, v14
    v_add_f32 v62, v62, v22
    v_exp_f32 v62, v62
    s_nop 0
    v_add_f32 v62, 1.0, v62
    v_rcp_f32 v62, v62
    v_cvt_f32_f16 v63, v95
    v_and_b32 v79, 0x3fff, v95
    v_or_b32 v79, 0x4000, v79
    v_cvt_f32_f16 v79, v79
    v_lshlrev_b32 v25, 17, v95
    v_and_b32 v25, 0x80000000, v25
    v_mul_f32 v79, 4.0, v79
    v_xor_b32 v79, v79, v25
    v_log_f32 v63, v63
    v_and_b32 v25, 0x8000, v95
    v_cmp_ne_u32 vcc, 0, v25
    v_max_f32 v63, 0xf149f2ca, v63
    s_nop 0
    v_cndmask_b32 v63, v63, v79, vcc
    v_fmac_f32 v63, v43, v15
    v_add_f32 v63, v63, v23
    v_exp_f32 v63, v63
    s_nop 0
    v_add_f32 v63, 1.0, v63
    v_rcp_f32 v63, v63
    v_fmac_f32 v36, v80, v48
    v_fmac_f32 v37, v81, v49
    v_fmac_f32 v38, v82, v50
    v_fmac_f32 v39, v83, v51
    v_fmac_f32 v36, v84, v52
    v_fmac_f32 v37, v85, v53
    v_fmac_f32 v38, v86, v54
    v_fmac_f32 v39, v87, v55
    v_fmac_f32 v36, v88, v56
    v_fmac_f32 v37, v89, v57
    v_fmac_f32 v38, v90, v58
    v_fmac_f32 v39, v91, v59
    v_fmac_f32 v36, v92, v60
    v_fmac_f32 v37, v93, v61
    v_fmac_f32 v38, v94, v62
    v_fmac_f32 v39, v95, v63
    ds_write_b128 v45, v[36:39]
    s_sub_u32 s40, s40, 1
    s_cmp_lg_u32 s40, 0
    s_cbranch_scc1 K2_SLP
    s_branch K2_MDONE
K2_LIMIT:
    s_cmp_eq_u32 s29, 0
    s_cselect_b32 s37, 16, 56
    s_branch K2_RESCAN
K2_PEND:
    s_mov_b32 s35, 1
    v_mov_b32 v24, 0
    v_mov_b32 v25, s30
    ds_write_b32 v24, v25 offset:12
    s_waitcnt lgkmcnt(0)
    s_mov_b64 exec, s[6:7]
    v_cmp_le_u32 s[6:7], s37, v104
    s_nop 3
    s_mov_b64 exec, s[52:53]
    v_cmp_le_u32 s[52:53], s37, v105
    s_nop 3
    s_mov_b64 exec, s[58:59]
    v_cmp_le_u32 s[58:59], s37, v106
    s_nop 3
    s_mov_b64 exec, s[60:61]
    v_cmp_le_u32 s[60:61], s37, v58
    s_nop 3
    s_mov_b64 exec, s[62:63]
    v_cmp_le_u32 s[62:63], s37, v59
    s_nop 3
    s_mov_b64 exec, s[64:65]
    v_cmp_le_u32 s[64:65], s37, v60
    s_nop 3
    s_mov_b64 exec, s[66:67]
    v_cmp_le_u32 s[66:67], s37, v61
    s_nop 3
    s_mov_b64 exec, s[68:69]
    v_cmp_le_u32 s[68:69], s37, v62
    s_nop 3
    s_mov_b64 exec, s[70:71]
    v_cmp_le_u32 s[70:71], s37, v63
    s_nop 3
    s_cmp_ge_i32 s51, 0
    s_cbranch_scc1 K2_PEND2
    s_mov_b64 exec, s[72:73]
    v_cmp_le_u32 s[72:73], s37, v64
    s_nop 3
    s_mov_b64 exec, s[74:75]
    v_cmp_le_u32 s[74:75], s37, v65
    s_nop 3
    s_mov_b64 exec, s[76:77]
    v_cmp_le_u32 s[76:77], s37, v66
    s_nop 3
    s_mov_b64 exec, s[78:79]
    v_cmp_le_u32 s[78:79], s37, v67
    s_nop 3
K2_PEND2:
    s_mov_b64 exec, -1
    s_branch K2_PDONE
K2_R2L:
    v_and_b32 v104, 0x8080, v27
    v_cmp_ne_u32 vcc, 0, v104
    s_cbranch_vccnz K2_OVFL
K2_OVFD:
    v_add_u32 v104, 8, v39
    v_bfe_u32 v105, v0, 2, 1
    v_lshlrev_b32 v106, 3, v105
    v_lshlrev_b32 v105, 4, v105
    v_bfe_u32 v106, v27, v106, 8
    v_cmp_lt_u32_sdwa s[72:73], v104, v27 src0_sel:DWORD src1_sel:BYTE_0
    v_cmp_lt_u32_sdwa s[76:77], v104, v27 src0_sel:DWORD src1_sel:BYTE_1
    v_add_u32 v106, v106, v105
    v_subrev_u32 v106, 32, v106
    s_mov_b32 exec_lo, 0x33333333
    s_mov_b32 exec_hi, 0x33333333
    v_cmp_lt_i32 s[6:7], v36, v106
    v_cmp_lt_i32 s[52:53], v37, v106
    v_cmp_lt_i32 s[58:59], v38, v106
    s_mov_b64 exec, -1
    s_waitcnt vmcnt(0)
    s_or_b64 s[32:33], s[72:73], s[76:77]
    s_cbranch_scc1 K2_R2M
K2_XS:
    s_mul_i32 s26, s29, 0x323232
    v_add_u32 v103, s26, v111
    v_mul_u32_u24_sdwa v100, v25, v103 dst_sel:DWORD dst_unused:UNUSED_PAD src0_sel:DWORD src1_sel:BYTE_0
    v_mul_u32_u24_sdwa v101, v25, v103 dst_sel:DWORD dst_unused:UNUSED_PAD src0_sel:DWORD src1_sel:BYTE_1
    v_mul_u32_u24_sdwa v102, v25, v103 dst_sel:DWORD dst_unused:UNUSED_PAD src0_sel:DWORD src1_sel:BYTE_2
    s_mov_b64 exec, s[6:7]
    ds_add_rtn_u32 v104, v100, v26 offset:36100
    s_mov_b64 exec, s[52:53]
    ds_add_rtn_u32 v105, v101, v26 offset:36100
    s_mov_b64 exec, s[58:59]
    ds_add_rtn_u32 v106, v102, v26 offset:36100
    s_waitcnt lgkmcnt(2)
    s_mov_b64 exec, s[6:7]
    v_min_u32 v104, 128, v104
    v_lshl_add_u32 v100, v104, 2, v100
    ds_write_b32 v100, v108 offset:35584
    s_waitcnt lgkmcnt(2)
    s_mov_b64 exec, s[52:53]
    v_min_u32 v105, 128, v105
    v_lshl_add_u32 v101, v105, 2, v101
    ds_write_b32 v101, v109 offset:35584
    s_waitcnt lgkmcnt(2)
    s_mov_b64 exec, s[58:59]
    v_min_u32 v106, 128, v106
    v_lshl_add_u32 v102, v106, 2, v102
    ds_write_b32 v102, v110 offset:35584
    s_mov_b64 exec, -1
    s_branch K2_SORT
K2_OVFL:
    v_mov_b32 v104, 0
    v_and_b32 v27, 0x7f7f, v27
    ds_write_b32 v104, v26 offset:4
    v_cmp_lt_u32_sdwa s[60:61], v36, v27 src0_sel:DWORD src1_sel:BYTE_0
    v_cmp_lt_u32_sdwa s[62:63], v37, v27 src0_sel:DWORD src1_sel:BYTE_0
    v_cmp_lt_u32_sdwa s[64:65], v38, v27 src0_sel:DWORD src1_sel:BYTE_0
    v_cmp_lt_u32_sdwa s[66:67], v36, v27 src0_sel:DWORD src1_sel:BYTE_1
    v_cmp_lt_u32_sdwa s[68:69], v37, v27 src0_sel:DWORD src1_sel:BYTE_1
    v_cmp_lt_u32_sdwa s[70:71], v38, v27 src0_sel:DWORD src1_sel:BYTE_1
    s_branch K2_OVFD
K2_R2M:
    v_mul_u32_u24 v100, 342, v38
    v_lshlrev_b32 v24, 4, v0
    v_lshrrev_b32 v100, 9, v100
    v_add_u32 v100, 40, v100
    v_cmp_lt_u32_sdwa s[74:75], v100, v27 src0_sel:DWORD src1_sel:BYTE_0
    v_cmp_lt_u32_sdwa s[78:79], v100, v27 src0_sel:DWORD src1_sel:BYTE_1
    s_nop 3
    s_mul_i32 s36, s2, 40064
    s_add_u32 s36, s36, 0xe00000
    s_or_b64 exec, s[72:73], s[74:75]
    buffer_load_dwordx4 v[40:43], v24, s[16:19], s36 offen
    s_add_u32 s36, s36, 15616
    s_or_b64 exec, s[76:77], s[78:79]
    buffer_load_dwordx4 v[44:47], v24, s[16:19], s36 offen
    s_mov_b64 exec, -1
    s_branch K2_XS
K2_SORT2:
    s_mov_b64 exec, -1
    s_mul_i32 s26, s29, 0x323232
    v_add_u32 v103, s26, v111
    v_mul_u32_u24_sdwa v100, v25, v103 dst_sel:DWORD dst_unused:UNUSED_PAD src0_sel:DWORD src1_sel:BYTE_0
    v_mul_u32_u24_sdwa v101, v25, v103 dst_sel:DWORD dst_unused:UNUSED_PAD src0_sel:DWORD src1_sel:BYTE_1
    v_mul_u32_u24_sdwa v102, v25, v103 dst_sel:DWORD dst_unused:UNUSED_PAD src0_sel:DWORD src1_sel:BYTE_2
    s_mov_b64 exec, s[6:7]
    ds_add_rtn_u32 v104, v100, v26 offset:36100
    s_mov_b64 exec, s[52:53]
    ds_add_rtn_u32 v105, v101, v26 offset:36100
    s_mov_b64 exec, s[58:59]
    ds_add_rtn_u32 v106, v102, v26 offset:36100
    s_waitcnt lgkmcnt(2)
    s_mov_b64 exec, s[6:7]
    v_min_u32 v104, 128, v104
    v_lshl_add_u32 v100, v104, 2, v100
    ds_write_b32 v100, v108 offset:35584
    s_waitcnt lgkmcnt(2)
    s_mov_b64 exec, s[52:53]
    v_min_u32 v105, 128, v105
    v_lshl_add_u32 v101, v105, 2, v101
    ds_write_b32 v101, v109 offset:35584
    s_waitcnt lgkmcnt(2)
    s_mov_b64 exec, s[58:59]
    v_min_u32 v106, 128, v106
    v_lshl_add_u32 v102, v106, 2, v102
    ds_write_b32 v102, v110 offset:35584
    s_mov_b64 exec, -1
    s_mul_i32 s26, s29, 26200
    s_mov_b64 exec, s[72:73]
    v_mul_u32_u24_sdwa v52, v25, v41 dst_sel:DWORD dst_unused:UNUSED_PAD src0_sel:DWORD src1_sel:WORD_0
    s_nop 0
    v_add_u32 v52, s26, v52
    ds_add_rtn_u32 v64, v52, v26 offset:36100
    s_mov_b64 exec, s[74:75]
    v_mul_u32_u24_sdwa v53, v25, v43 dst_sel:DWORD dst_unused:UNUSED_PAD src0_sel:DWORD src1_sel:WORD_0
    s_nop 0
    v_add_u32 v53, s26, v53
    ds_add_rtn_u32 v65, v53, v26 offset:36100
    s_mov_b64 exec, s[76:77]
    v_mul_u32_u24_sdwa v54, v25, v45 dst_sel:DWORD dst_unused:UNUSED_PAD src0_sel:DWORD src1_sel:WORD_0
    s_nop 0
    v_add_u32 v54, s26, v54
    ds_add_rtn_u32 v66, v54, v26 offset:36100
    s_mov_b64 exec, s[78:79]
    v_mul_u32_u24_sdwa v55, v25, v47 dst_sel:DWORD dst_unused:UNUSED_PAD src0_sel:DWORD src1_sel:WORD_0
    s_nop 0
    v_add_u32 v55, s26, v55
    ds_add_rtn_u32 v67, v55, v26 offset:36100
    s_waitcnt lgkmcnt(0)
    s_mov_b64 exec, s[72:73]
    v_min_u32 v64, 128, v64
    v_lshl_add_u32 v52, v64, 2, v52
    ds_write_b32 v52, v40 offset:35584
    s_mov_b64 exec, s[74:75]
    v_min_u32 v65, 128, v65
    v_lshl_add_u32 v53, v65, 2, v53
    ds_write_b32 v53, v42 offset:35584
    s_mov_b64 exec, s[76:77]
    v_min_u32 v66, 128, v66
    v_lshl_add_u32 v54, v66, 2, v54
    ds_write_b32 v54, v44 offset:35584
    s_mov_b64 exec, s[78:79]
    v_min_u32 v67, 128, v67
    v_lshl_add_u32 v55, v67, 2, v55
    ds_write_b32 v55, v46 offset:35584
    s_branch K2_L2SKIP
K2_LWR:
    s_waitcnt vmcnt(8) lgkmcnt(0)
    s_mov_b32 s36, 0
    s_lshl_b32 s25, s3, 7
    s_mov_b64 exec, s[72:73]
    v_mbcnt_lo_u32_b32 v26, exec_lo, 0
    v_mbcnt_hi_u32_b32 v26, exec_hi, v26
    v_add_u32 v26, s36, v26
    s_bcnt1_i32_b64 s26, exec
    s_add_u32 s36, s36, s26
    v_cmp_gt_u32 vcc, s51, v26
    v_lshl_add_u32 v26, v26, 3, s25
    s_andn2_b64 s[72:73], exec, vcc
    s_mov_b64 exec, vcc
    ds_write_b64 v26, v[40:41] offset:768
    s_mov_b64 exec, s[74:75]
    v_mbcnt_lo_u32_b32 v26, exec_lo, 0
    v_mbcnt_hi_u32_b32 v26, exec_hi, v26
    v_add_u32 v26, s36, v26
    s_bcnt1_i32_b64 s26, exec
    s_add_u32 s36, s36, s26
    v_cmp_gt_u32 vcc, s51, v26
    v_lshl_add_u32 v26, v26, 3, s25
    s_andn2_b64 s[74:75], exec, vcc
    s_mov_b64 exec, vcc
    ds_write_b64 v26, v[42:43] offset:768
    s_mov_b64 exec, s[76:77]
    v_mbcnt_lo_u32_b32 v26, exec_lo, 0
    v_mbcnt_hi_u32_b32 v26, exec_hi, v26
    v_add_u32 v26, s36, v26
    s_bcnt1_i32_b64 s26, exec
    s_add_u32 s36, s36, s26
    v_cmp_gt_u32 vcc, s51, v26
    v_lshl_add_u32 v26, v26, 3, s25
    s_andn2_b64 s[76:77], exec, vcc
    s_mov_b64 exec, vcc
    ds_write_b64 v26, v[44:45] offset:768
    s_mov_b64 exec, s[78:79]
    v_mbcnt_lo_u32_b32 v26, exec_lo, 0
    v_mbcnt_hi_u32_b32 v26, exec_hi, v26
    v_add_u32 v26, s36, v26
    s_bcnt1_i32_b64 s26, exec
    s_add_u32 s36, s36, s26
    v_cmp_gt_u32 vcc, s51, v26
    v_lshl_add_u32 v26, v26, 3, s25
    s_andn2_b64 s[78:79], exec, vcc
    s_mov_b64 exec, vcc
    ds_write_b64 v26, v[46:47] offset:768
    s_mov_b64 exec, -1
    s_cmp_le_u32 s36, s51
    s_cbranch_scc1 K2_LNOL
    v_mov_b32 v24, 0
    v_mov_b32 v25, 1
    ds_write_b32 v24, v25 offset:8
    s_mov_b32 s36, s51
    s_cmp_eq_u32 s36, 0
    s_cbranch_scc1 K2_LWD
K2_LNOL:
    v_mov_b32 v48, 0
K2_SPU:
    ds_read_b32 v49, v48 offset:32
    s_waitcnt lgkmcnt(0)
    v_cmp_gt_u32 vcc, s38, v49
    s_cbranch_vccnz K2_SPU
    v_lshrrev_b32 v49, 1, v6
    v_add_u32 v49, 16384, v49
    global_load_dwordx2 v[52:53], v49, s[4:5]
    v_lshrrev_b32 v48, 4, v1
    v_mov_b32 v55, v6
    v_mov_b32 v68, 0x40000000
K2_LLP:
    v_cmp_gt_u32 vcc, s36, v48
    v_lshl_add_u32 v49, v48, 3, s25
    s_mov_b64 exec, vcc
    ds_read_b64 v[50:51], v49 offset:768
    s_waitcnt lgkmcnt(0)
    v_and_b32 v54, 0xffff, v50
    v_and_b32 v51, 0xffff, v51
    buffer_load_dwordx4 v[56:59], v[54:55], s[12:15], 0 idxen offen
    v_lshl_add_u32 v51, v51, 8, v6
    ds_read_b128 v[60:63], v51 offset:2816
    v_and_b32 v50, 0xffff0000, v50
    v_mul_f32 v50, 0xbfb8aa3b, v50
    s_waitcnt vmcnt(1)
    v_lshlrev_b32 v64, 16, v52
    v_and_b32 v65, 0xffff0000, v52
    v_lshlrev_b32 v66, 16, v53
    v_and_b32 v67, 0xffff0000, v53
    v_fma_f32 v64, v64, v50, v68
    v_fma_f32 v65, v65, v50, v68
    v_fma_f32 v66, v66, v50, v68
    v_fma_f32 v67, v67, v50, v68
    v_exp_f32 v64, v64
    v_exp_f32 v65, v65
    v_exp_f32 v66, v66
    v_exp_f32 v67, v67
    s_waitcnt vmcnt(0) lgkmcnt(0)
    v_fma_mix_f32 v64, v56, v64, v60 op_sel_hi:[1,0,0]
    v_fma_mix_f32 v65, v57, v65, v61 op_sel_hi:[1,0,0]
    v_fma_mix_f32 v66, v58, v66, v62 op_sel_hi:[1,0,0]
    v_fma_mix_f32 v67, v59, v67, v63 op_sel_hi:[1,0,0]
    v_rcp_f32 v64, v64
    v_rcp_f32 v65, v65
    v_rcp_f32 v66, v66
    v_rcp_f32 v67, v67
    v_mul_f32 v64, v64, v60
    v_mul_f32 v65, v65, v61
    v_mul_f32 v66, v66, v62
    v_mul_f32 v67, v67, v63
    v_mul_f32 v64, v64, v56
    v_mul_f32 v65, v65, v57
    v_mul_f32 v66, v66, v58
    v_mul_f32 v67, v67, v59
    ds_add_f32 v51, v64 offset:19200
    ds_add_f32 v51, v65 offset:19204
    ds_add_f32 v51, v66 offset:19208
    ds_add_f32 v51, v67 offset:19212
    s_mov_b64 exec, -1
    v_add_u32 v48, 4, v48
    v_cmp_gt_u32 vcc, s36, v48
    s_cbranch_vccnz K2_LLP
    s_branch K2_LWD
K2_RARE:
    v_readfirstlane_b32 s37, v72
    v_readfirstlane_b32 s36, v73
    v_readfirstlane_b32 s26, v74
    v_readfirstlane_b32 s27, v75
    s_andn2_b32 s37, s37, s31
    s_cbranch_scc1 K2_GOSAFE
    s_cmp_eq_u32 s31, 0
    s_cbranch_scc1 K2_RARE1
    v_mov_b32 v68, 1.0
    v_mov_b32 v69, 1.0
    v_mov_b32 v70, 1.0
    v_mov_b32 v71, 1.0
K2_RARE1:
    v_pk_fma_f32 v[40:41], v[64:65], v[68:69], v[40:41]
    v_pk_fma_f32 v[42:43], v[66:67], v[70:71], v[42:43]
    ds_write_b128 v46, v[40:43] offset:19200
    s_cmp_lg_u32 s35, 0
    s_cbranch_scc1 K2_RARE3
    s_mov_b64 s[60:61], 0
    s_mov_b64 s[62:63], 0
    s_mov_b64 s[64:65], 0
    s_mov_b64 s[66:67], 0
    s_mov_b64 s[68:69], 0
    s_mov_b64 s[70:71], 0
    s_mov_b64 s[6:7], 0
    s_mov_b64 s[52:53], 0
    s_mov_b64 s[58:59], 0
    s_cmp_ge_i32 s51, 0
    s_cbranch_scc1 K2_RARE3
    s_mov_b64 s[72:73], 0
    s_mov_b64 s[74:75], 0
    s_mov_b64 s[76:77], 0
    s_mov_b64 s[78:79], 0
K2_RARE3:
    s_cmp_lt_i32 s51, 0
    s_cselect_b32 s25, 0, s26
    s_mov_b32 s51, -1
    s_cmp_eq_u32 s27, s30
    s_cbranch_scc1 K2_AGAIN
    s_cmp_lg_u32 s25, 0
    s_cbranch_scc1 K2_AGAIN
    s_cmp_eq_u32 s36, 0
    s_cbranch_scc1 K2_FIN
    s_cmp_ge_i32 s34, 0
    s_cbranch_scc1 K2_NXC
    v_cmp_gt_u32 vcc, 250, v0
    v_lshlrev_b32 v24, 7, v0
    v_mul_u32_u24 v25, 25600, v0
    s_mul_i32 s24, s2, 40064
    s_add_u32 s24, s24, 0x400000
    s_mov_b32 s25, 0x18063f8
    s_mov_b64 exec, vcc
    buffer_load_dword v26, v24, s[16:19], s24 offen offset:12
    buffer_load_dword v25, v25, s[16:19], s25 offen
    v_lshlrev_b32 v24, 2, v0
    v_add_u32 v24, 110592, v24
    s_waitcnt vmcnt(0)
    v_cmp_gt_i32 vcc, 0, v26
    s_nop 1
    v_cndmask_b32 v25, 0, v25, vcc
    ds_write_b32 v24, v25
    s_mov_b64 exec, -1
    s_waitcnt lgkmcnt(0)
    s_barrier
K2_NXC:
    s_add_u32 s34, s34, 1
    s_cmp_ge_u32 s34, 250
    s_cbranch_scc1 K2_FIN
    s_lshl_b32 s25, s34, 2
    s_add_u32 s25, s25, 110592
    v_mov_b32 v24, s25
    ds_read_b32 v25, v24
    s_waitcnt lgkmcnt(0)
    v_readfirstlane_b32 s25, v25
    s_cmp_eq_u32 s25, 0
    s_cbranch_scc1 K2_NXC
    v_lshrrev_b32 v24, 2, v0
    v_and_b32 v25, 3, v0
    v_lshlrev_b32 v24, 4, v24
    v_lshl_add_u32 v24, v25, 1, v24
    v_sub_u32 v70, s25, v24
    v_cmp_lt_i32 s[72:73], 0, v70
    v_cmp_lt_i32 s[74:75], 1, v70
    v_cmp_lt_i32 s[76:77], 8, v70
    v_cmp_lt_i32 s[78:79], 9, v70
K2_AGAIN:
    s_barrier
    v_mov_b32 v72, 0
    v_mov_b32 v73, 0
    v_mov_b32 v74, 0
    v_mov_b32 v75, 0
    ds_write_b32 v2, v72 offset:36100
    s_cmp_ge_i32 s34, 0
    s_cbranch_scc1 K2_AGOV
    s_mov_b64 s[32:33], s[6:7]
    s_mov_b32 s36, s11
    v_lshlrev_b32 v24, 4, v0
    s_mul_i32 s24, s2, 40064
    s_add_u32 s24, s24, 0x400000
    s_add_u32 s25, s24, 15616
    v_mov_b32 v35, 0
    v_cmp_le_u32 vcc, 48, v0
    v_bfe_u32 v100, v0, 2, 1
    v_and_b32 v101, 0x3f8, v0
    v_mul_u32_u24 v100, 3904, v100
    v_and_or_b32 v102, v24, 16, v100
    s_add_u32 s11, s24, 32000
    s_mov_b32 s6, 0x33333333
    s_mov_b32 s7, s6
    v_lshl_add_u32 v100, v101, 2, v102
    buffer_load_dwordx4 v[28:31], v24, s[16:19], s24 offen
    s_mov_b64 exec, vcc
    buffer_load_dwordx4 v[32:35], v24, s[16:19], s25 offen
    s_mov_b64 exec, s[6:7]
    buffer_load_dwordx4 v[108:111], v100, s[16:19], s11 offen
    s_mov_b64 exec, -1
    s_mov_b64 s[6:7], s[32:33]
    s_mov_b32 s11, s36
    s_mul_i32 s36, s2, 40064
    s_add_u32 s36, s36, 0xe00000
    s_or_b64 exec, s[72:73], s[74:75]
    buffer_load_dwordx4 v[40:43], v24, s[16:19], s36 offen
    s_add_u32 s36, s36, 15616
    s_or_b64 exec, s[76:77], s[78:79]
    buffer_load_dwordx4 v[44:47], v24, s[16:19], s36 offen
    s_mov_b64 exec, -1
    v_mov_b32 v25, 524
    v_mov_b32 v26, 1
    s_waitcnt vmcnt(0) lgkmcnt(0)
    s_barrier
    s_branch K2_SORT
K2_AGOV:
    v_lshrrev_b32 v24, 2, v0
    v_and_b32 v25, 3, v0
    v_lshlrev_b32 v24, 7, v24
    v_lshl_add_u32 v24, v25, 4, v24
    s_mul_i32 s36, s34, 25600
    s_add_u32 s36, s36, 0x1800000
    s_or_b64 exec, s[72:73], s[74:75]
    buffer_load_dwordx4 v[40:43], v24, s[16:19], s36 offen offset:0
    s_or_b64 exec, s[76:77], s[78:79]
    buffer_load_dwordx4 v[44:47], v24, s[16:19], s36 offen offset:64
    s_mov_b64 exec, -1
    v_mov_b32 v25, 524
    v_mov_b32 v26, 1
    s_waitcnt vmcnt(0) lgkmcnt(0)
    s_mov_b64 exec, s[72:73]
    v_lshrrev_b32 v24, 16, v41
    v_cmp_eq_u32 s[72:73], s2, v24
    s_nop 3
    s_mov_b64 exec, s[74:75]
    v_lshrrev_b32 v24, 16, v43
    v_cmp_eq_u32 s[74:75], s2, v24
    s_nop 3
    s_mov_b64 exec, s[76:77]
    v_lshrrev_b32 v24, 16, v45
    v_cmp_eq_u32 s[76:77], s2, v24
    s_nop 3
    s_mov_b64 exec, s[78:79]
    v_lshrrev_b32 v24, 16, v47
    v_cmp_eq_u32 s[78:79], s2, v24
    s_nop 3
    s_mov_b64 exec, -1
    s_barrier
    s_branch K2_SORT
K2_GOSAFE:
    s_mov_b32 s31, 1
    s_mov_b32 s51, 0
    v_lshrrev_b32 v24, 1, v6
    v_add_u32 v24, 16384, v24
    global_load_dwordx2 v[14:15], v24, s[4:5]
    s_waitcnt vmcnt(0) lgkmcnt(0)
    v_lshlrev_b32 v12, 16, v14
    v_and_b32 v13, 0xffff0000, v14
    v_lshlrev_b32 v14, 16, v15
    v_and_b32 v15, 0xffff0000, v15
    v_mul_f32 v12, 0xbfb8aa3b, v12
    v_mul_f32 v13, 0xbfb8aa3b, v13
    v_mul_f32 v14, 0xbfb8aa3b, v14
    v_mul_f32 v15, 0xbfb8aa3b, v15
    s_setprio 0
    s_barrier
    s_branch K2_SRC0
.p2align 12
.section .rodata,"a"
.p2align 6
.amdhsa_kernel egc_bin_kernel
  .amdhsa_next_free_vgpr 128
  .amdhsa_next_free_sgpr 80
  .amdhsa_accum_offset 128
  .amdhsa_group_segment_fixed_size 0
  .amdhsa_kernarg_size 80
  .amdhsa_user_sgpr_count 2
  .amdhsa_user_sgpr_kernarg_segment_ptr 1
  .amdhsa_system_sgpr_workgroup_id_x 1
.end_amdhsa_kernel
.p2align 6
.amdhsa_kernel egc_main_kernel
  .amdhsa_next_free_vgpr 128
  .amdhsa_next_free_sgpr 80
  .amdhsa_accum_offset 128
  .amdhsa_group_segment_fixed_size 0
  .amdhsa_kernarg_size 80
  .amdhsa_user_sgpr_count 2
  .amdhsa_user_sgpr_kernarg_segment_ptr 1
  .amdhsa_system_sgpr_workgroup_id_x 1
.end_amdhsa_kernel
```
